```python
import torch

def _softmax(x, axis=-1):
    return torch.softmax(x, dim=axis)

def _gelu(x):
    return torch.nn.functional.gelu(x, approximate='tanh')

def _silu(x):
    return torch.nn.functional.silu(x)

def _sigmoid(x):
    return torch.sigmoid(x)

def _layernorm(x, axis=-1, eps=1e-05):
    m = x.mean(dim=axis, keepdim=True)
    v = x.var(dim=axis, keepdim=True, unbiased=False)
    return (x - m) / torch.sqrt(v + eps)

def _scatter_add(tgt, idx, src, axis=0):
    return tgt.clone().index_add_(axis, idx, src)

def _segment_sum(src, seg, n):
    out = torch.zeros((n,) + src.shape[1:], dtype=src.dtype)
    return out.index_add_(0, seg, src)

def _pad(x, pw):
    flat = tuple((v for pair in reversed(pw) for v in pair))
    return torch.nn.functional.pad(x, flat)
kernel_name = 'concat_heads__sliding_block__memory_aug_recurrent_mem_tr__prompt'

def setup_inputs():

    _w = lambda a: (lambda t: t.to(torch.bfloat16) if t.is_floating_point() else t)(torch.as_tensor(a))

    def _A_setup():
        B, S, D = (1, 2048, 640)
        return {'x': _w((lambda *s: torch.randn(*s, dtype=torch.bfloat16) * 0.2)(B, S, D)), 'wqkv': _w((lambda *s: torch.randn(*s, dtype=torch.bfloat16) * 0.2)(D, 3 * D)), 'wo': _w((lambda *s: torch.randn(*s, dtype=torch.bfloat16) * 0.05)(D, D))}
    _A_in = _A_setup()

    def _B_setup():
        B, S, Dm = (1, 2048, 640)
        H, Dh = (32, 128)
        M, seg = (8, 32)
        seg = min(seg, S)
        S = S // seg * seg
        return {'x': _w((lambda *s: torch.randn(*s, dtype=torch.bfloat16) * 0.05)(B, S, Dm)), 'mem0': _w((lambda *s: torch.randn(*s, dtype=torch.bfloat16) * 1.6)(B, M, Dm)), 'Wq': _w((lambda *s: torch.randn(*s, dtype=torch.bfloat16) * 0.8)(Dm, H, Dh) * Dm ** (-0.5)), 'Wk': _w((lambda *s: torch.randn(*s, dtype=torch.bfloat16) * 0.8)(Dm, H, Dh) * Dm ** (-0.5)), 'Wv': _w((lambda *s: torch.randn(*s, dtype=torch.bfloat16) * 1.6)(Dm, H, Dh) * Dm ** (-0.5)), 'Wo': _w((lambda *s: torch.randn(*s, dtype=torch.bfloat16) * 1.6)(H, Dh, Dm) * (H * Dh) ** (-0.5)), 'seg_len': seg}
    _B_in = _B_setup()
    return {'A_x': _A_in['x'], 'A_wqkv': _A_in['wqkv'], 'A_wo': _A_in['wo'], 'B_x': _B_in['x'], 'B_mem0': _B_in['mem0'], 'B_Wq': _B_in['Wq'], 'B_Wk': _B_in['Wk'], 'B_Wv': _B_in['Wv'], 'B_Wo': _B_in['Wo'], 'B_seg_len': _B_in['seg_len']}

def reference(A_x, A_wqkv, A_wo, B_x, B_mem0, B_Wq, B_Wk, B_Wv, B_Wo, B_seg_len):

    def _A_ref(x, wqkv, wo):
        B, S, D = x.shape
        H = 32
        Dh = D // H
        W = 256
        qkv = (lambda x, *d: x.permute(*d))((x @ wqkv).reshape(B, S, 3, H, Dh), 2, 0, 3, 1, 4)
        q, k, v = (qkv[0], qkv[1], qkv[2])
        scores = torch.einsum('bhqd,bhkd->bhqk', q, k) * Dh ** (-0.5)
        idx = torch.arange(S)
        mask = (idx[:, None] - idx[None, :] >= 0) & (idx[:, None] - idx[None, :] < W)
        scores = torch.where(mask[None, None], scores, -1000000000.0)
        p = _softmax(scores, axis=-1)
        o = torch.einsum('bhqk,bhkd->bhqd', p, v)
        return (lambda x, *d: x.permute(*d))(o, 0, 2, 1, 3).reshape(B, S, D) @ wo

    def _B_ref(x, mem0, Wq, Wk, Wv, Wo, seg_len):
        B, S, Dm = x.shape
        H, Dh = (Wq.shape[1], Wq.shape[2])
        M = mem0.shape[1]
        scale = Dh ** (-0.5)
        n_seg = S // seg_len
        L = M + seg_len
        idx = torch.arange(L)
        mask = (idx[:, None] < M) | (idx[:, None] >= idx[None, :])
        mem = mem0
        outs = []
        for s in range(n_seg):
            xs = x[:, s * seg_len:(s + 1) * seg_len, :].clone()
            h = torch.concatenate([mem, xs], axis=1)
            q = torch.einsum('btd,dhe->bhte', h, Wq)
            k = torch.einsum('btd,dhe->bhte', h, Wk)
            v = torch.einsum('btd,dhe->bhte', h, Wv)
            scores = torch.einsum('bhqe,bhke->bhqk', q, k) * scale
            scores = torch.where(mask[None, None], scores, -1000000000.0)
            p = _softmax(scores, axis=-1)
            o = torch.einsum('bhqk,bhke->bhqe', p, v)
            o = torch.einsum('bhte,hed->btd', o, Wo)
            mem = o[:, :M, :].clone()
            outs.append(o[:, M:, :])
        return torch.concatenate(outs, axis=1)
    a = _A_ref(A_x, A_wqkv, A_wo)
    b = _B_ref(B_x, B_mem0, B_Wq, B_Wk, B_Wv, B_Wo, B_seg_len)
    return torch.concatenate([a, b], axis=-1)
```

```asm
; @launch grid=(256,1,1) block=(512,1,1) lds=163840
.amdgcn_target "amdgcn-amd-amdhsa--gfx950"
.text
.globl concat_heads__sliding_block__memory_aug_recurrent_mem_tr__prompt_kernel
.p2align 8
.type concat_heads__sliding_block__memory_aug_recurrent_mem_tr__prompt_kernel,@function
concat_heads__sliding_block__memory_aug_recurrent_mem_tr__prompt_kernel:
  s_cmp_ge_u32 s2, 256
  s_cbranch_scc1 L_END
  s_load_dwordx16 s[28:43], s[0:1], 0
  s_load_dwordx2 s[44:45], s[0:1], 64
  s_load_dwordx2 s[16:17], s[0:1], 80
  s_load_dwordx2 s[12:13], s[0:1], 88
  s_load_dwordx2 s[8:9], s[0:1], 96
  s_getreg_b32 s4, hwreg(HW_REG_XCC_ID, 0, 3)
  v_lshrrev_b32 v2, 6, v0
  v_and_b32 v1, 63, v0
  v_readfirstlane_b32 s3, v2
  s_waitcnt lgkmcnt(0)
  s_mov_b32 s10, 0x10000000
  s_mov_b32 s11, 0x20000
  s_mov_b32 s14, 256
  s_mov_b32 s15, 0x20000
  s_mov_b32 s18, 5242880
  s_mov_b32 s19, 0x20000
  s_mov_b32 s20, s38
  s_mov_b32 s21, s39
  s_mov_b32 s22, 0x500000
  s_mov_b32 s23, 0x20000
  s_mov_b32 s24, s34
  s_mov_b32 s25, s35
  s_mov_b32 s26, 0x280000
  s_mov_b32 s27, 0x20000
  s_cmp_lt_u32 s3, 3
  s_cbranch_scc1 L_mi_end
  v_lshlrev_b32 v2, 4, v1
  s_cmp_eq_u32 s3, 3
  s_cbranch_scc1 L_mi_mem
  v_mov_b32 v4, -1
  v_mov_b32 v5, -1
  v_mov_b32 v6, -1
  v_mov_b32 v7, -1
  s_lshl_b32 s48, s2, 2
  s_add_u32 s48, s48, s3
  s_sub_u32 s48, s48, 4
  s_lshl_b32 s48, s48, 10
  buffer_store_dwordx4 v[4:7], v2, s[8:11], s48 offen sc1
  s_cmp_eq_u32 s3, 7
  s_cbranch_scc1 L_mi_end
  s_mul_i32 s48, s2, 3
  s_add_u32 s48, s48, s3
  s_sub_u32 s48, s48, 4
  s_cmp_lt_u32 s48, 640
  s_cbranch_scc0 L_mi_h3
  s_mul_i32 s49, s48, 410
  s_lshr_b32 s49, s49, 16
  s_mul_i32 s50, s49, 160
  s_sub_u32 s48, s48, s50
  s_lshl_b32 s48, s48, 10
  s_lshl_b32 s49, s49, 18
  s_add_u32 s48, s48, s49
  s_add_u32 s48, s48, 0x8400000
  buffer_store_dwordx4 v[4:7], v2, s[8:11], s48 offen sc1
  s_branch L_mi_end
L_mi_h3:
  s_sub_u32 s48, s48, 600
  s_cmp_lt_u32 s48, 160
  s_cbranch_scc0 L_mi_end
  s_mul_i32 s49, s48, 6554
  s_lshr_b32 s49, s49, 16
  s_mul_i32 s50, s49, 10
  s_sub_u32 s48, s48, s50
  s_lshl_b32 s48, s48, 10
  s_lshl_b32 s49, s49, 14
  s_add_u32 s48, s48, s49
  s_add_u32 s48, s48, 0x210000
  buffer_store_dwordx4 v[4:7], v2, s[8:11], s48 offen sc1
  s_branch L_mi_end
L_mi_mem:
  s_cmp_lt_u32 s2, 40
  s_cbranch_scc0 L_mi_end
  s_mov_b32 s52, s36
  s_mov_b32 s53, s37
  s_mov_b32 s54, 10240
  s_mov_b32 s55, 0x20000
  s_mul_i32 s49, s2, 6554
  s_lshr_b32 s49, s49, 16
  s_mul_i32 s50, s49, 10
  s_sub_u32 s48, s2, s50
  v_and_b32 v3, 7, v1
  v_mul_u32_u24 v3, 1280, v3
  v_lshrrev_b32 v4, 3, v1
  v_lshl_add_u32 v3, v4, 4, v3
  s_lshl_b32 s50, s48, 7
  buffer_load_dwordx4 v[4:7], v3, s[52:55], s50 offen
  s_lshl_b32 s48, s48, 10
  s_lshl_b32 s49, s49, 14
  s_add_u32 s48, s48, s49
  s_add_u32 s48, s48, 0x210000
  s_waitcnt vmcnt(0)
  v_min_u32 v4, -2, v4
  v_min_u32 v5, -2, v5
  v_min_u32 v6, -2, v6
  v_min_u32 v7, -2, v7
  buffer_store_dwordx4 v[4:7], v2, s[8:11], s48 offen sc1
L_mi_end:
  s_cmp_eq_u32 s3, 0
  s_cbranch_scc0 L_st_notw0
  s_lshl_b32 s6, s4, 5
  v_mov_b32 v2, s6
  v_mov_b32 v3, 1
  v_mov_b32 v4, 0
  s_mov_b64 exec, 1
  buffer_atomic_add v3, v2, s[12:15], 0 offen sc0
  s_waitcnt vmcnt(0)
  ds_write_b32 v4, v3
  s_mov_b64 exec, -1
  s_waitcnt lgkmcnt(0)
  s_branch L_st_join
L_st_notw0:
  s_cmp_eq_u32 s3, 1
  s_cbranch_scc0 L_st_join
  s_lshl_b32 s6, s2, 9
  s_add_u32 s6, s6, 0x280000
  v_lshlrev_b32 v2, 3, v1
  v_mov_b32 v4, 0
  v_mov_b32 v5, 0
  buffer_store_dwordx2 v[4:5], v2, s[8:11], s6 offen sc1
  s_waitcnt vmcnt(0)
L_st_join:
  s_waitcnt vmcnt(0)
  s_barrier
  v_mov_b32 v4, 0
  ds_read_b32 v3, v4
  s_waitcnt lgkmcnt(0)
  v_readfirstlane_b32 s5, v3
  s_barrier
  s_cmp_lt_u32 s5, 32
  s_cbranch_scc1 L_ov_end
  v_lshlrev_b32 v2, 5, v1
  s_mov_b32 s48, 65536
L_ov_poll:
  buffer_load_dword v3, v2, s[12:15], 0 offen sc1
  s_waitcnt vmcnt(0)
  s_mov_b32 s49, 0
  v_readlane_b32 s52, v3, 0
  s_add_u32 s49, s49, s52
  v_readlane_b32 s53, v3, 1
  s_add_u32 s49, s49, s53
  v_readlane_b32 s54, v3, 2
  s_add_u32 s49, s49, s54
  v_readlane_b32 s55, v3, 3
  s_add_u32 s49, s49, s55
  v_readlane_b32 s56, v3, 4
  s_add_u32 s49, s49, s56
  v_readlane_b32 s57, v3, 5
  s_add_u32 s49, s49, s57
  v_readlane_b32 s58, v3, 6
  s_add_u32 s49, s49, s58
  v_readlane_b32 s59, v3, 7
  s_add_u32 s49, s49, s59
  s_cmp_ge_u32 s49, 256
  s_cbranch_scc1 L_ov_go
  s_sleep 8
  s_sub_u32 s48, s48, 1
  s_cmp_lg_u32 s48, 0
  s_cbranch_scc1 L_ov_poll
  s_endpgm
L_ov_go:
  s_sub_u32 s49, s5, 32
  s_max_u32 s50, s52, 32
  s_sub_u32 s50, s50, 32
  s_cmp_gt_u32 s4, 0
  s_cselect_b32 s50, s50, 0
  s_add_u32 s49, s49, s50
  s_max_u32 s50, s53, 32
  s_sub_u32 s50, s50, 32
  s_cmp_gt_u32 s4, 1
  s_cselect_b32 s50, s50, 0
  s_add_u32 s49, s49, s50
  s_max_u32 s50, s54, 32
  s_sub_u32 s50, s50, 32
  s_cmp_gt_u32 s4, 2
  s_cselect_b32 s50, s50, 0
  s_add_u32 s49, s49, s50
  s_max_u32 s50, s55, 32
  s_sub_u32 s50, s50, 32
  s_cmp_gt_u32 s4, 3
  s_cselect_b32 s50, s50, 0
  s_add_u32 s49, s49, s50
  s_max_u32 s50, s56, 32
  s_sub_u32 s50, s50, 32
  s_cmp_gt_u32 s4, 4
  s_cselect_b32 s50, s50, 0
  s_add_u32 s49, s49, s50
  s_max_u32 s50, s57, 32
  s_sub_u32 s50, s50, 32
  s_cmp_gt_u32 s4, 5
  s_cselect_b32 s50, s50, 0
  s_add_u32 s49, s49, s50
  s_max_u32 s50, s58, 32
  s_sub_u32 s50, s50, 32
  s_cmp_gt_u32 s4, 6
  s_cselect_b32 s50, s50, 0
  s_add_u32 s49, s49, s50
  s_min_u32 s50, s52, 32
  s_sub_u32 s51, 32, s50
  s_mov_b32 s4, 0
  s_add_u32 s5, s50, s49
  s_cmp_lt_u32 s49, s51
  s_cbranch_scc1 L_ov_set
  s_sub_u32 s49, s49, s51
  s_min_u32 s50, s53, 32
  s_sub_u32 s51, 32, s50
  s_mov_b32 s4, 1
  s_add_u32 s5, s50, s49
  s_cmp_lt_u32 s49, s51
  s_cbranch_scc1 L_ov_set
  s_sub_u32 s49, s49, s51
  s_min_u32 s50, s54, 32
  s_sub_u32 s51, 32, s50
  s_mov_b32 s4, 2
  s_add_u32 s5, s50, s49
  s_cmp_lt_u32 s49, s51
  s_cbranch_scc1 L_ov_set
  s_sub_u32 s49, s49, s51
  s_min_u32 s50, s55, 32
  s_sub_u32 s51, 32, s50
  s_mov_b32 s4, 3
  s_add_u32 s5, s50, s49
  s_cmp_lt_u32 s49, s51
  s_cbranch_scc1 L_ov_set
  s_sub_u32 s49, s49, s51
  s_min_u32 s50, s56, 32
  s_sub_u32 s51, 32, s50
  s_mov_b32 s4, 4
  s_add_u32 s5, s50, s49
  s_cmp_lt_u32 s49, s51
  s_cbranch_scc1 L_ov_set
  s_sub_u32 s49, s49, s51
  s_min_u32 s50, s57, 32
  s_sub_u32 s51, 32, s50
  s_mov_b32 s4, 5
  s_add_u32 s5, s50, s49
  s_cmp_lt_u32 s49, s51
  s_cbranch_scc1 L_ov_set
  s_sub_u32 s49, s49, s51
  s_min_u32 s50, s58, 32
  s_sub_u32 s51, 32, s50
  s_mov_b32 s4, 6
  s_add_u32 s5, s50, s49
  s_cmp_lt_u32 s49, s51
  s_cbranch_scc1 L_ov_set
  s_sub_u32 s49, s49, s51
  s_min_u32 s50, s59, 32
  s_sub_u32 s51, 32, s50
  s_mov_b32 s4, 7
  s_add_u32 s5, s50, s49
  s_cmp_lt_u32 s49, s51
  s_cbranch_scc1 L_ov_set
  s_sub_u32 s49, s49, s51
  s_endpgm
L_ov_set:
  v_mov_b32 v2, 12
  v_mov_b32 v3, 1
  s_mov_b64 exec, 1
  buffer_atomic_or v3, v2, s[12:15], 0 offen
  s_mov_b64 exec, -1
  s_waitcnt vmcnt(0)
  s_barrier
L_ov_end:
  s_cmp_eq_u32 s3, 1
  s_cbranch_scc0 L_st_nra
  s_lshl_b32 s6, s4, 5
  s_add_u32 s6, s6, 4
  v_mov_b32 v2, s6
  v_mov_b32 v3, 1
  s_mov_b64 exec, 1
  buffer_atomic_add v3, v2, s[12:15], 0 offen
  s_mov_b64 exec, -1
L_st_nra:
  s_cmp_lt_u32 s4, 4
  s_cbranch_scc1 L_CHAIN
  s_sub_u32 s46, s4, 4
  s_lshl_b32 s46, s46, 5
  s_add_u32 s46, s46, s5
  v_mov_b32 v10, 0
  v_mov_b32 v11, 0
  s_mov_b32 s47, 0
  s_cmp_lt_u32 s46, 96
  s_cbranch_scc0 L_b_A
  s_lshr_b32 s6, s46, 5
  s_add_u32 s6, s6, 1
  s_cmp_eq_u32 s6, 3
  s_cselect_b32 s6, 0, s6
  s_and_b32 s7, s46, 31
  s_cmp_eq_u32 s6, 1
  s_cselect_b32 s20, s40, s38
  s_cselect_b32 s21, s41, s39
  s_cmp_eq_u32 s6, 2
  s_cselect_b32 s20, s42, s20
  s_cselect_b32 s21, s43, s21
  s_lshl_b32 s48, s7, 8
  s_mov_b32 s49, 8192
  s_mov_b32 s50, 0
  s_mov_b32 s51, 32
  s_mov_b32 s52, 0
  s_mov_b32 s68, s7
  s_mov_b32 s69, 320
  s_mov_b32 s70, 31
  s_lshl_b32 s6, s6, 5
  s_add_u32 s6, s6, s7
  s_lshl_b32 s53, s6, 13
  s_add_u32 s53, s53, 0x400000
  s_mov_b32 s54, 786432
  s_lshl_b32 s6, s6, 3
  s_add_u32 s6, s6, s3
  s_lshl_b32 s6, s6, 2
  s_add_u32 s55, s6, 0x280000
  s_and_b32 s6, s3, 3
  s_lshl_b32 s6, s6, 11
  v_bfe_u32 v12, v1, 4, 1
  v_lshlrev_b32 v12, 10, v12
  v_lshrrev_b32 v13, 5, v1
  v_lshl_add_u32 v12, v13, 8, v12
  v_and_b32 v13, 15, v1
  v_lshl_add_u32 v12, v13, 4, v12
  v_add_u32 v8, s6, v12
  v_add_u32 v9, 512, v8
  s_branch L_b_sg
L_b_A:
  s_cmp_lt_u32 s46, 126
  s_cbranch_scc0 L_b_idle
  s_mov_b32 s20, s30
  s_mov_b32 s21, s31
  s_mov_b32 s22, 0x258000
  s_mov_b32 s23, 0x20000
  s_mov_b32 s24, s28
  s_mov_b32 s25, s29
  s_mov_b32 s26, 0x280000
  s_mov_b32 s27, 0x20000
  s_sub_u32 s6, s46, 96
  s_cmp_ge_u32 s6, 15
  s_cselect_b32 s7, 1, 0
  s_mul_i32 s60, s7, 15
  s_sub_u32 s6, s6, s60
  s_lshl_b32 s48, s6, 8
  s_mov_b32 s49, 3840
  s_lshl_b32 s50, s7, 5
  s_mov_b32 s51, 16
  s_cmp_ge_u32 s6, 10
  s_cselect_b32 s52, 2, 0
  s_mov_b32 s68, s6
  s_mov_b32 s69, 704
  s_mov_b32 s70, 0x7ff
  s_lshl_b32 s6, s6, 2
  s_and_b32 s7, s3, 3
  s_add_u32 s6, s6, s7
  s_lshl_b32 s55, s46, 3
  s_add_u32 s55, s55, s3
  s_lshl_b32 s55, s55, 2
  s_add_u32 s55, s55, 0x282000
  s_cmp_eq_u32 s52, 2
  s_cbranch_scc1 L_a1_v
  s_mov_b32 s54, 512
  s_lshl_b32 s53, s50, 9
  s_lshl_b32 s6, s6, 17
  s_add_u32 s53, s53, s6
  s_add_u32 s53, s53, 0x9400000
  v_lshrrev_b32 v12, 5, v1
  v_lshlrev_b32 v12, 15, v12
  v_and_b32 v13, 31, v1
  v_lshl_add_u32 v8, v13, 4, v12
  v_add_u32 v9, 0x10000, v8
  s_branch L_a1_j
L_a1_v:
  s_mov_b32 s54, 1280
  s_mul_i32 s53, s50, 1280
  s_add_u32 s53, s53, 0x9900000
  s_sub_u32 s6, s6, 40
  s_lshl_b32 s6, s6, 5
  v_and_b32 v12, 19, v1
  v_bfe_u32 v13, v1, 2, 1
  v_lshl_add_u32 v12, v13, 3, v12
  v_bfe_u32 v13, v1, 3, 1
  v_lshl_add_u32 v12, v13, 2, v12
  v_add_u32 v12, s6, v12
  v_mul_u32_u24 v13, 3277, v12
  v_lshrrev_b32 v13, 16, v13
  v_mul_u32_u24 v14, 20, v13
  v_sub_u32 v12, v12, v14
  v_mul_u32_u24 v13, 81920, v13
  v_lshl_add_u32 v13, v12, 4, v13
  v_lshrrev_b32 v14, 5, v1
  v_mul_u32_u24 v14, 320, v14
  v_add_u32 v8, v13, v14
  v_add_u32 v9, 640, v8
L_a1_j:
L_b_sg:
  v_lshrrev_b32 v12, 4, v1
  v_lshlrev_b32 v13, 2, v12
  v_and_b32 v14, 15, v1
  v_xor_b32 v13, v13, v14
  v_lshlrev_b32 v13, 4, v13
  v_mul_lo_u32 v12, v12, s49
  v_add3_u32 v12, v12, v13, s48
  s_mul_i32 s60, s3, 10
  s_lshl_b32 s61, s49, 2
  s_mul_i32 s58, s60, s61
  s_lshl_b32 s59, s60, 10
  s_mov_b32 m0, s59
  s_nop 0
  buffer_load_dwordx4 v12, s[20:23], s58 offen lds
  s_add_u32 s59, s59, 1024
  s_add_u32 s58, s58, s61
  s_mov_b32 m0, s59
  s_nop 0
  buffer_load_dwordx4 v12, s[20:23], s58 offen lds
  s_add_u32 s59, s59, 1024
  s_add_u32 s58, s58, s61
  s_mov_b32 m0, s59
  s_nop 0
  buffer_load_dwordx4 v12, s[20:23], s58 offen lds
  s_add_u32 s59, s59, 1024
  s_add_u32 s58, s58, s61
  s_mov_b32 m0, s59
  s_nop 0
  buffer_load_dwordx4 v12, s[20:23], s58 offen lds
  s_add_u32 s59, s59, 1024
  s_add_u32 s58, s58, s61
  s_mov_b32 m0, s59
  s_nop 0
  buffer_load_dwordx4 v12, s[20:23], s58 offen lds
  s_add_u32 s59, s59, 1024
  s_add_u32 s58, s58, s61
  s_mov_b32 m0, s59
  s_nop 0
  buffer_load_dwordx4 v12, s[20:23], s58 offen lds
  s_add_u32 s59, s59, 1024
  s_add_u32 s58, s58, s61
  s_mov_b32 m0, s59
  s_nop 0
  buffer_load_dwordx4 v12, s[20:23], s58 offen lds
  s_add_u32 s59, s59, 1024
  s_add_u32 s58, s58, s61
  s_mov_b32 m0, s59
  s_nop 0
  buffer_load_dwordx4 v12, s[20:23], s58 offen lds
  s_add_u32 s59, s59, 1024
  s_add_u32 s58, s58, s61
  s_mov_b32 m0, s59
  s_nop 0
  buffer_load_dwordx4 v12, s[20:23], s58 offen lds
  s_add_u32 s59, s59, 1024
  s_add_u32 s58, s58, s61
  s_mov_b32 m0, s59
  s_nop 0
  buffer_load_dwordx4 v12, s[20:23], s58 offen lds
  s_add_u32 s59, s59, 1024
  s_add_u32 s58, s58, s61
  s_add_u32 s59, s59, 71680
  s_mul_i32 s60, s61, 70
  s_add_u32 s58, s58, s60
  s_mov_b32 m0, s59
  s_nop 0
  buffer_load_dwordx4 v12, s[20:23], s58 offen lds
  s_add_u32 s59, s59, 1024
  s_add_u32 s58, s58, s61
  s_mov_b32 m0, s59
  s_nop 0
  buffer_load_dwordx4 v12, s[20:23], s58 offen lds
  s_add_u32 s59, s59, 1024
  s_add_u32 s58, s58, s61
  s_mov_b32 m0, s59
  s_nop 0
  buffer_load_dwordx4 v12, s[20:23], s58 offen lds
  s_add_u32 s59, s59, 1024
  s_add_u32 s58, s58, s61
  s_mov_b32 m0, s59
  s_nop 0
  buffer_load_dwordx4 v12, s[20:23], s58 offen lds
  s_add_u32 s59, s59, 1024
  s_add_u32 s58, s58, s61
  s_mov_b32 m0, s59
  s_nop 0
  buffer_load_dwordx4 v12, s[20:23], s58 offen lds
  s_add_u32 s59, s59, 1024
  s_add_u32 s58, s58, s61
  s_mov_b32 m0, s59
  s_nop 0
  buffer_load_dwordx4 v12, s[20:23], s58 offen lds
  s_add_u32 s59, s59, 1024
  s_add_u32 s58, s58, s61
  s_mov_b32 m0, s59
  s_nop 0
  buffer_load_dwordx4 v12, s[20:23], s58 offen lds
  s_add_u32 s59, s59, 1024
  s_add_u32 s58, s58, s61
  s_mov_b32 m0, s59
  s_nop 0
  buffer_load_dwordx4 v12, s[20:23], s58 offen lds
  s_add_u32 s59, s59, 1024
  s_add_u32 s58, s58, s61
  s_mov_b32 m0, s59
  s_nop 0
  buffer_load_dwordx4 v12, s[20:23], s58 offen lds
  s_add_u32 s59, s59, 1024
  s_add_u32 s58, s58, s61
  s_mov_b32 m0, s59
  s_nop 0
  buffer_load_dwordx4 v12, s[20:23], s58 offen lds
  s_add_u32 s59, s59, 1024
  s_add_u32 s58, s58, s61
  s_and_b32 s64, s3, 3
  s_lshr_b32 s63, s3, 2
  v_bfe_u32 v13, v1, 2, 2
  v_xor_b32 v14, s64, v13
  v_lshlrev_b32 v14, 6, v14
  v_lshl_add_u32 v14, v13, 8, v14
  v_bfe_u32 v13, v1, 4, 1
  v_lshl_add_u32 v14, v13, 5, v14
  v_bfe_u32 v13, v1, 5, 1
  v_lshl_add_u32 v14, v13, 11, v14
  v_and_b32 v13, 1, v1
  v_lshl_add_u32 v14, v13, 4, v14
  v_bfe_u32 v13, v1, 1, 1
  v_lshl_add_u32 v14, v13, 3, v14
  v_add_u32 v15, 0xa000, v14
  v_lshrrev_b32 v12, 3, v1
  s_lshl_b32 s60, s64, 3
  v_add_u32 v12, s60, v12
  v_lshrrev_b32 v13, 1, v12
  v_xor_b32 v13, v13, v1
  v_and_b32 v13, 7, v13
  v_lshlrev_b32 v13, 4, v13
  v_mul_u32_u24 v12, 1280, v12
  v_add_u32 v6, v12, v13
  s_mov_b32 s60, s68
  s_lshl_b32 s60, s60, 3
  s_add_u32 s60, s60, s3
  s_mul_i32 s60, s60, s69
  s_mul_i32 s61, s63, 40960
  s_sub_u32 s60, s60, s61
  s_add_u32 s60, s60, 162560
  v_lshlrev_b32 v64, 6, v1
  v_add_u32 v64, s60, v64
  s_mul_i32 s60, s50, 40960
  s_mul_i32 s61, s63, 40960
  s_add_u32 s60, s60, s61
  s_add_u32 s60, s60, 1280
  v_subrev_u32 v13, 81920, v64
  s_mov_b32 exec_lo, s70
  s_mov_b32 exec_hi, 0
  buffer_load_dword v65, v13, s[24:27], s60 offen
  buffer_load_dword v65, v64, s[24:27], s60 offen
  s_mov_b64 exec, -1
  v_and_b32 v12, 31, v1
  v_lshlrev_b32 v13, 7, v12
  v_bfe_u32 v12, v1, 1, 3
  v_lshrrev_b32 v7, 5, v1
  v_xor_b32 v12, v12, v7
  s_mul_i32 s60, s63, 40960
  v_xor_b32 v7, 0, v12
  v_lshl_add_u32 v7, v7, 4, v13
  v_add_u32 v2, s60, v7
  v_xor_b32 v7, 2, v12
  v_lshl_add_u32 v7, v7, 4, v13
  v_add_u32 v3, s60, v7
  v_xor_b32 v7, 4, v12
  v_lshl_add_u32 v7, v7, 4, v13
  v_add_u32 v4, s60, v7
  v_xor_b32 v7, 6, v12
  v_lshl_add_u32 v7, v7, 4, v13
  v_add_u32 v5, s60, v7
  s_waitcnt vmcnt(12)
  s_barrier
  ds_read_b64_tr_b16 v[96:97], v14 offset:0
  ds_read_b64_tr_b16 v[98:99], v14 offset:1024
  ds_read_b64_tr_b16 v[100:101], v14 offset:4096
  ds_read_b64_tr_b16 v[102:103], v14 offset:5120
  ds_read_b64_tr_b16 v[104:105], v14 offset:8192
  ds_read_b64_tr_b16 v[106:107], v14 offset:9216
  ds_read_b64_tr_b16 v[108:109], v14 offset:12288
  ds_read_b64_tr_b16 v[110:111], v14 offset:13312
  s_waitcnt lgkmcnt(0)
  ds_read_b64_tr_b16 v[112:113], v14 offset:16384
  ds_read_b64_tr_b16 v[114:115], v14 offset:17408
  ds_read_b64_tr_b16 v[116:117], v14 offset:20480
  ds_read_b64_tr_b16 v[118:119], v14 offset:21504
  ds_read_b64_tr_b16 v[120:121], v14 offset:24576
  ds_read_b64_tr_b16 v[122:123], v14 offset:25600
  ds_read_b64_tr_b16 v[124:125], v14 offset:28672
  ds_read_b64_tr_b16 v[126:127], v14 offset:29696
  s_waitcnt lgkmcnt(0)
  ds_read_b64_tr_b16 v[128:129], v14 offset:32768
  ds_read_b64_tr_b16 v[130:131], v14 offset:33792
  ds_read_b64_tr_b16 v[132:133], v14 offset:36864
  ds_read_b64_tr_b16 v[134:135], v14 offset:37888
  ds_read_b64_tr_b16 v[136:137], v15 offset:0
  ds_read_b64_tr_b16 v[138:139], v15 offset:1024
  ds_read_b64_tr_b16 v[140:141], v15 offset:4096
  ds_read_b64_tr_b16 v[142:143], v15 offset:5120
  s_waitcnt lgkmcnt(0)
  ds_read_b64_tr_b16 v[144:145], v15 offset:8192
  ds_read_b64_tr_b16 v[146:147], v15 offset:9216
  ds_read_b64_tr_b16 v[148:149], v15 offset:12288
  ds_read_b64_tr_b16 v[150:151], v15 offset:13312
  ds_read_b64_tr_b16 v[152:153], v15 offset:16384
  ds_read_b64_tr_b16 v[154:155], v15 offset:17408
  ds_read_b64_tr_b16 v[156:157], v15 offset:20480
  ds_read_b64_tr_b16 v[158:159], v15 offset:21504
  s_waitcnt lgkmcnt(0)
  ds_read_b64_tr_b16 v[160:161], v15 offset:24576
  ds_read_b64_tr_b16 v[162:163], v15 offset:25600
  ds_read_b64_tr_b16 v[164:165], v15 offset:28672
  ds_read_b64_tr_b16 v[166:167], v15 offset:29696
  ds_read_b64_tr_b16 v[168:169], v15 offset:32768
  ds_read_b64_tr_b16 v[170:171], v15 offset:33792
  ds_read_b64_tr_b16 v[172:173], v15 offset:36864
  ds_read_b64_tr_b16 v[174:175], v15 offset:37888
  s_waitcnt lgkmcnt(0)
  s_waitcnt lgkmcnt(0)
  s_barrier
  v_add_u32 v14, 0x14000, v14
  v_add_u32 v15, 0x14000, v15
  s_mov_b32 s56, 0
  s_add_u32 s60, s50, s63
  s_mul_i32 s59, s63, 40960
  s_mul_i32 s58, s60, 40960
  s_lshl_b32 s60, s64, 10
  s_add_u32 s59, s59, s60
  s_mov_b32 m0, s59
  s_add_u32 s59, s59, 4096
  buffer_load_dwordx4 v6, s[24:27], s58 offen sc1 lds
  s_add_u32 s58, s58, 128
  s_mov_b32 m0, s59
  s_add_u32 s59, s59, 4096
  buffer_load_dwordx4 v6, s[24:27], s58 offen sc1 lds
  s_add_u32 s58, s58, 128
  s_mov_b32 m0, s59
  s_add_u32 s59, s59, 4096
  buffer_load_dwordx4 v6, s[24:27], s58 offen sc1 lds
  s_add_u32 s58, s58, 128
  s_mov_b32 m0, s59
  s_add_u32 s59, s59, 4096
  buffer_load_dwordx4 v6, s[24:27], s58 offen sc1 lds
  s_add_u32 s58, s58, 128
  s_mov_b32 m0, s59
  s_add_u32 s59, s59, 4096
  buffer_load_dwordx4 v6, s[24:27], s58 offen sc1 lds
  s_add_u32 s58, s58, 128
  s_mov_b32 m0, s59
  s_add_u32 s59, s59, 4096
  buffer_load_dwordx4 v6, s[24:27], s58 offen sc1 lds
  s_add_u32 s58, s58, 128
  s_mov_b32 m0, s59
  s_add_u32 s59, s59, 4096
  buffer_load_dwordx4 v6, s[24:27], s58 offen sc1 lds
  s_add_u32 s58, s58, 128
  s_mov_b32 m0, s59
  s_add_u32 s59, s59, 4096
  buffer_load_dwordx4 v6, s[24:27], s58 offen sc1 lds
  s_add_u32 s58, s58, 128
  s_mov_b32 m0, s59
  s_add_u32 s59, s59, 4096
  buffer_load_dwordx4 v6, s[24:27], s58 offen sc1 lds
  s_add_u32 s58, s58, 128
  s_mov_b32 m0, s59
  s_add_u32 s59, s59, 4096
  buffer_load_dwordx4 v6, s[24:27], s58 offen sc1 lds
  s_add_u32 s58, s58, 128
  s_waitcnt vmcnt(10)
  s_barrier
  ds_read_b64_tr_b16 v[176:177], v14 offset:0
  ds_read_b64_tr_b16 v[178:179], v14 offset:1024
  ds_read_b64_tr_b16 v[180:181], v14 offset:4096
  ds_read_b64_tr_b16 v[182:183], v14 offset:5120
  ds_read_b64_tr_b16 v[184:185], v14 offset:8192
  ds_read_b64_tr_b16 v[186:187], v14 offset:9216
  ds_read_b64_tr_b16 v[188:189], v14 offset:12288
  ds_read_b64_tr_b16 v[190:191], v14 offset:13312
  s_waitcnt lgkmcnt(0)
  ds_read_b64_tr_b16 v[192:193], v14 offset:16384
  ds_read_b64_tr_b16 v[194:195], v14 offset:17408
  ds_read_b64_tr_b16 v[196:197], v14 offset:20480
  ds_read_b64_tr_b16 v[198:199], v14 offset:21504
  ds_read_b64_tr_b16 v[200:201], v14 offset:24576
  ds_read_b64_tr_b16 v[202:203], v14 offset:25600
  ds_read_b64_tr_b16 v[204:205], v14 offset:28672
  ds_read_b64_tr_b16 v[206:207], v14 offset:29696
  s_waitcnt lgkmcnt(0)
  ds_read_b64_tr_b16 v[208:209], v14 offset:32768
  ds_read_b64_tr_b16 v[210:211], v14 offset:33792
  ds_read_b64_tr_b16 v[212:213], v14 offset:36864
  ds_read_b64_tr_b16 v[214:215], v14 offset:37888
  ds_read_b64_tr_b16 v[216:217], v15 offset:0
  ds_read_b64_tr_b16 v[218:219], v15 offset:1024
  ds_read_b64_tr_b16 v[220:221], v15 offset:4096
  ds_read_b64_tr_b16 v[222:223], v15 offset:5120
  s_waitcnt lgkmcnt(0)
  ds_read_b64_tr_b16 v[224:225], v15 offset:8192
  ds_read_b64_tr_b16 v[226:227], v15 offset:9216
  ds_read_b64_tr_b16 v[228:229], v15 offset:12288
  ds_read_b64_tr_b16 v[230:231], v15 offset:13312
  ds_read_b64_tr_b16 v[232:233], v15 offset:16384
  ds_read_b64_tr_b16 v[234:235], v15 offset:17408
  ds_read_b64_tr_b16 v[236:237], v15 offset:20480
  ds_read_b64_tr_b16 v[238:239], v15 offset:21504
  s_waitcnt lgkmcnt(0)
  ds_read_b64_tr_b16 v[240:241], v15 offset:24576
  ds_read_b64_tr_b16 v[242:243], v15 offset:25600
  ds_read_b64_tr_b16 v[244:245], v15 offset:28672
  ds_read_b64_tr_b16 v[246:247], v15 offset:29696
  ds_read_b64_tr_b16 v[248:249], v15 offset:32768
  ds_read_b64_tr_b16 v[250:251], v15 offset:33792
  ds_read_b64_tr_b16 v[252:253], v15 offset:36864
  ds_read_b64_tr_b16 v[254:255], v15 offset:37888
  s_waitcnt lgkmcnt(0)
  s_waitcnt lgkmcnt(0)
  s_barrier
  s_mov_b32 s57, 81920
  s_mul_i32 s62, s63, s54
  s_add_u32 s62, s62, s53
  s_mov_b32 s74, 0xe0000000
  v_lshlrev_b32 v12, 5, v1
  s_mov_b32 s73, 65536
L_rdy_1:
  buffer_load_dword v13, v12, s[12:15], 0 offen offset:4 sc1
  s_waitcnt vmcnt(0)
  v_readlane_b32 s71, v13, 0
  v_readlane_b32 s72, v13, 1
  s_add_u32 s71, s71, s72
  v_readlane_b32 s72, v13, 2
  s_add_u32 s71, s71, s72
  v_readlane_b32 s72, v13, 3
  s_add_u32 s71, s71, s72
  v_readlane_b32 s72, v13, 4
  s_add_u32 s71, s71, s72
  v_readlane_b32 s72, v13, 5
  s_add_u32 s71, s71, s72
  v_readlane_b32 s72, v13, 6
  s_add_u32 s71, s71, s72
  v_readlane_b32 s72, v13, 7
  s_add_u32 s71, s71, s72
  s_cmp_ge_u32 s71, 256
  s_cbranch_scc1 L_rdyd_2
  s_sleep 8
  s_sub_u32 s73, s73, 1
  s_cmp_lg_u32 s73, 0
  s_cbranch_scc1 L_rdy_1
  s_endpgm
L_rdyd_2:
  s_barrier
  ds_read_b128 v[32:35], v2 offset:0
  ds_read_b128 v[36:39], v3 offset:0
  ds_read_b128 v[40:43], v4 offset:0
  ds_read_b128 v[44:47], v5 offset:0
  s_cmp_eq_u32 s52, 2
  s_cbranch_scc1 L_sg_sw
L_sg_no:
  s_lshl_b32 s60, s56, 1
  s_add_u32 s60, s60, 2
  s_add_u32 s60, s60, s50
  s_add_u32 s60, s60, s63
  s_bitcmp0_b32 s56, 0
  s_cselect_b32 s59, 2, 0
  s_add_u32 s59, s59, s63
  s_mul_i32 s59, s59, 40960
  s_mul_i32 s58, s60, 40960
  s_lshl_b32 s60, s64, 10
  s_add_u32 s59, s59, s60
  ds_read_b128 v[48:51], v2 offset:4096
  s_waitcnt lgkmcnt(4)
  v_mfma_f32_32x32x16_bf16 v[16:31], v[96:99], v[32:35], 0
  ds_read_b128 v[32:35], v3 offset:4096
  s_waitcnt lgkmcnt(4)
  v_mfma_f32_32x32x16_bf16 v[16:31], v[100:103], v[36:39], v[16:31]
  v_cvt_pk_bf16_f32 v56, v72, v73
  v_cvt_pk_bf16_f32 v57, v74, v75
  v_cvt_pk_bf16_f32 v58, v76, v77
  v_cvt_pk_bf16_f32 v59, v78, v79
  ds_read_b128 v[36:39], v4 offset:4096
  s_waitcnt lgkmcnt(4)
  v_mfma_f32_32x32x16_bf16 v[16:31], v[104:107], v[40:43], v[16:31]
  v_cvt_pk_bf16_f32 v60, v80, v81
  v_cvt_pk_bf16_f32 v61, v82, v83
  v_cvt_pk_bf16_f32 v62, v84, v85
  v_cvt_pk_bf16_f32 v63, v86, v87
  s_barrier
  ds_read_b128 v[40:43], v5 offset:4096
  s_waitcnt lgkmcnt(4)
  v_mfma_f32_32x32x16_bf16 v[16:31], v[108:111], v[44:47], v[16:31]
  s_cmp_eq_u32 s52, 3
  s_cbranch_scc1 L_e3_3
  buffer_store_dwordx4 v[56:59], v8, s[8:11], s74 offen sc1
  buffer_store_dwordx4 v[60:63], v9, s[8:11], s74 offen sc1
  s_branch L_ee_4
L_e3_3:
  buffer_store_dwordx4 v[56:59], v8, s[16:19], s74 offen
  buffer_store_dwordx4 v[60:63], v9, s[16:19], s74 offen
L_ee_4:
  s_mov_b32 s74, s62
  s_lshl_b32 s60, s54, 1
  s_add_u32 s62, s62, s60
  ds_read_b128 v[44:47], v2 offset:8192
  s_waitcnt lgkmcnt(4)
  v_mfma_f32_32x32x16_bf16 v[16:31], v[112:115], v[48:51], v[16:31]
  s_mov_b32 m0, s59
  s_add_u32 s59, s59, 4096
  buffer_load_dwordx4 v6, s[24:27], s58 offen sc1 lds
  s_add_u32 s58, s58, 128
  ds_read_b128 v[48:51], v3 offset:8192
  s_waitcnt lgkmcnt(4)
  v_mfma_f32_32x32x16_bf16 v[16:31], v[116:119], v[32:35], v[16:31]
  ds_read_b128 v[32:35], v4 offset:8192
  s_waitcnt lgkmcnt(4)
  v_mfma_f32_32x32x16_bf16 v[16:31], v[120:123], v[36:39], v[16:31]
  s_mov_b32 m0, s59
  s_add_u32 s59, s59, 4096
  buffer_load_dwordx4 v6, s[24:27], s58 offen sc1 lds
  s_add_u32 s58, s58, 128
  ds_read_b128 v[36:39], v5 offset:8192
  s_waitcnt lgkmcnt(4)
  v_mfma_f32_32x32x16_bf16 v[16:31], v[124:127], v[40:43], v[16:31]
  ds_read_b128 v[40:43], v2 offset:12288
  s_waitcnt lgkmcnt(4)
  v_mfma_f32_32x32x16_bf16 v[16:31], v[128:131], v[44:47], v[16:31]
  s_mov_b32 m0, s59
  s_add_u32 s59, s59, 4096
  buffer_load_dwordx4 v6, s[24:27], s58 offen sc1 lds
  s_add_u32 s58, s58, 128
  ds_read_b128 v[44:47], v3 offset:12288
  s_waitcnt lgkmcnt(4)
  v_mfma_f32_32x32x16_bf16 v[16:31], v[132:135], v[48:51], v[16:31]
  s_cmp_lt_u32 s56, 3
  s_cbranch_scc0 L_ef_5
  s_waitcnt vmcnt(3)
  v_mov_b32 v12, s56
  v_mov_b32 v13, s55
  s_mov_b64 exec, 1
  buffer_store_dword v12, v13, s[8:11], 0 offen sc1
  s_mov_b64 exec, -1
L_ef_5:
  ds_read_b128 v[48:51], v4 offset:12288
  s_waitcnt lgkmcnt(4)
  v_mfma_f32_32x32x16_bf16 v[16:31], v[136:139], v[32:35], v[16:31]
  s_mov_b32 m0, s59
  s_add_u32 s59, s59, 4096
  buffer_load_dwordx4 v6, s[24:27], s58 offen sc1 lds
  s_add_u32 s58, s58, 128
  ds_read_b128 v[32:35], v5 offset:12288
  s_waitcnt lgkmcnt(4)
  v_mfma_f32_32x32x16_bf16 v[16:31], v[140:143], v[36:39], v[16:31]
  ds_read_b128 v[36:39], v2 offset:16384
  s_waitcnt lgkmcnt(4)
  v_mfma_f32_32x32x16_bf16 v[16:31], v[144:147], v[40:43], v[16:31]
  s_mov_b32 m0, s59
  s_add_u32 s59, s59, 4096
  buffer_load_dwordx4 v6, s[24:27], s58 offen sc1 lds
  s_add_u32 s58, s58, 128
  ds_read_b128 v[40:43], v3 offset:16384
  s_waitcnt lgkmcnt(4)
  v_mfma_f32_32x32x16_bf16 v[16:31], v[148:151], v[44:47], v[16:31]
  ds_read_b128 v[44:47], v4 offset:16384
  s_waitcnt lgkmcnt(4)
  v_mfma_f32_32x32x16_bf16 v[16:31], v[152:155], v[48:51], v[16:31]
  s_mov_b32 m0, s59
  s_add_u32 s59, s59, 4096
  buffer_load_dwordx4 v6, s[24:27], s58 offen sc1 lds
  s_add_u32 s58, s58, 128
  ds_read_b128 v[48:51], v5 offset:16384
  s_waitcnt lgkmcnt(4)
  v_mfma_f32_32x32x16_bf16 v[16:31], v[156:159], v[32:35], v[16:31]
  ds_read_b128 v[32:35], v2 offset:20480
  s_waitcnt lgkmcnt(4)
  v_mfma_f32_32x32x16_bf16 v[16:31], v[160:163], v[36:39], v[16:31]
  s_mov_b32 m0, s59
  s_add_u32 s59, s59, 4096
  buffer_load_dwordx4 v6, s[24:27], s58 offen sc1 lds
  s_add_u32 s58, s58, 128
  ds_read_b128 v[36:39], v3 offset:20480
  s_waitcnt lgkmcnt(4)
  v_mfma_f32_32x32x16_bf16 v[16:31], v[164:167], v[40:43], v[16:31]
  ds_read_b128 v[40:43], v4 offset:20480
  s_waitcnt lgkmcnt(4)
  v_mfma_f32_32x32x16_bf16 v[16:31], v[168:171], v[44:47], v[16:31]
  s_mov_b32 m0, s59
  s_add_u32 s59, s59, 4096
  buffer_load_dwordx4 v6, s[24:27], s58 offen sc1 lds
  s_add_u32 s58, s58, 128
  ds_read_b128 v[44:47], v5 offset:20480
  s_waitcnt lgkmcnt(4)
  v_mfma_f32_32x32x16_bf16 v[16:31], v[172:175], v[48:51], v[16:31]
  ds_read_b128 v[48:51], v2 offset:24576
  s_waitcnt lgkmcnt(4)
  v_mfma_f32_32x32x16_bf16 v[16:31], v[176:179], v[32:35], v[16:31]
  s_mov_b32 m0, s59
  s_add_u32 s59, s59, 4096
  buffer_load_dwordx4 v6, s[24:27], s58 offen sc1 lds
  s_add_u32 s58, s58, 128
  ds_read_b128 v[32:35], v3 offset:24576
  s_waitcnt lgkmcnt(4)
  v_mfma_f32_32x32x16_bf16 v[16:31], v[180:183], v[36:39], v[16:31]
  ds_read_b128 v[36:39], v4 offset:24576
  s_waitcnt lgkmcnt(4)
  v_mfma_f32_32x32x16_bf16 v[16:31], v[184:187], v[40:43], v[16:31]
  s_mov_b32 m0, s59
  s_add_u32 s59, s59, 4096
  buffer_load_dwordx4 v6, s[24:27], s58 offen sc1 lds
  s_add_u32 s58, s58, 128
  ds_read_b128 v[40:43], v5 offset:24576
  s_waitcnt lgkmcnt(4)
  v_mfma_f32_32x32x16_bf16 v[16:31], v[188:191], v[44:47], v[16:31]
  s_waitcnt vmcnt(10)
  v_mov_b32 v12, s56
  v_mov_b32 v13, s55
  s_mov_b64 exec, 1
  buffer_store_dword v12, v13, s[8:11], 0 offen sc1
  s_mov_b64 exec, -1
  ds_read_b128 v[44:47], v2 offset:28672
  s_waitcnt lgkmcnt(4)
  v_mfma_f32_32x32x16_bf16 v[16:31], v[192:195], v[48:51], v[16:31]
  ds_read_b128 v[48:51], v3 offset:28672
  s_waitcnt lgkmcnt(4)
  v_mfma_f32_32x32x16_bf16 v[16:31], v[196:199], v[32:35], v[16:31]
  ds_read_b128 v[32:35], v4 offset:28672
  s_waitcnt lgkmcnt(4)
  v_mfma_f32_32x32x16_bf16 v[16:31], v[200:203], v[36:39], v[16:31]
  s_mov_b32 exec_lo, s70
  s_mov_b32 exec_hi, 0
  buffer_load_dword v65, v64, s[24:27], s58 offen
  s_mov_b64 exec, -1
  ds_read_b128 v[36:39], v5 offset:28672
  s_waitcnt lgkmcnt(4)
  v_mfma_f32_32x32x16_bf16 v[16:31], v[204:207], v[40:43], v[16:31]
  ds_read_b128 v[40:43], v2 offset:32768
  s_waitcnt lgkmcnt(4)
  v_mfma_f32_32x32x16_bf16 v[16:31], v[208:211], v[44:47], v[16:31]
  ds_read_b128 v[44:47], v3 offset:32768
  s_waitcnt lgkmcnt(4)
  v_mfma_f32_32x32x16_bf16 v[16:31], v[212:215], v[48:51], v[16:31]
  ds_read_b128 v[48:51], v4 offset:32768
  s_waitcnt lgkmcnt(4)
  v_mfma_f32_32x32x16_bf16 v[16:31], v[216:219], v[32:35], v[16:31]
  ds_read_b128 v[32:35], v5 offset:32768
  s_waitcnt lgkmcnt(4)
  v_mfma_f32_32x32x16_bf16 v[16:31], v[220:223], v[36:39], v[16:31]
  ds_read_b128 v[36:39], v2 offset:36864
  s_waitcnt lgkmcnt(4)
  v_mfma_f32_32x32x16_bf16 v[16:31], v[224:227], v[40:43], v[16:31]
  ds_read_b128 v[40:43], v3 offset:36864
  s_waitcnt lgkmcnt(4)
  v_mfma_f32_32x32x16_bf16 v[16:31], v[228:231], v[44:47], v[16:31]
  ds_read_b128 v[44:47], v4 offset:36864
  s_waitcnt lgkmcnt(4)
  v_mfma_f32_32x32x16_bf16 v[16:31], v[232:235], v[48:51], v[16:31]
  ds_read_b128 v[48:51], v5 offset:36864
  s_waitcnt lgkmcnt(4)
  v_mfma_f32_32x32x16_bf16 v[16:31], v[236:239], v[32:35], v[16:31]
  v_add_u32 v2, s57, v2
  v_add_u32 v3, s57, v3
  v_add_u32 v4, s57, v4
  v_add_u32 v5, s57, v5
  s_sub_u32 s57, 0, s57
  s_waitcnt vmcnt(2)
  s_barrier
  ds_read_b128 v[32:35], v2 offset:0
  s_waitcnt lgkmcnt(4)
  v_mfma_f32_32x32x16_bf16 v[16:31], v[240:243], v[36:39], v[16:31]
  ds_read_b128 v[36:39], v3 offset:0
  s_waitcnt lgkmcnt(4)
  v_mfma_f32_32x32x16_bf16 v[16:31], v[244:247], v[40:43], v[16:31]
  ds_read_b128 v[40:43], v4 offset:0
  s_waitcnt lgkmcnt(4)
  v_mfma_f32_32x32x16_bf16 v[16:31], v[248:251], v[44:47], v[16:31]
  ds_read_b128 v[44:47], v5 offset:0
  s_waitcnt lgkmcnt(4)
  v_mfma_f32_32x32x16_bf16 v[16:31], v[252:255], v[48:51], v[16:31]
  s_add_u32 s56, s56, 1
  s_cmp_lt_u32 s56, s51
  s_cbranch_scc0 L_sg_endA
  s_lshl_b32 s60, s56, 1
  s_add_u32 s60, s60, 2
  s_add_u32 s60, s60, s50
  s_add_u32 s60, s60, s63
  s_bitcmp0_b32 s56, 0
  s_cselect_b32 s59, 2, 0
  s_add_u32 s59, s59, s63
  s_mul_i32 s59, s59, 40960
  s_mul_i32 s58, s60, 40960
  s_lshl_b32 s60, s64, 10
  s_add_u32 s59, s59, s60
  ds_read_b128 v[48:51], v2 offset:4096
  s_waitcnt lgkmcnt(4)
  v_mfma_f32_32x32x16_bf16 v[72:87], v[96:99], v[32:35], 0
  ds_read_b128 v[32:35], v3 offset:4096
  s_waitcnt lgkmcnt(4)
  v_mfma_f32_32x32x16_bf16 v[72:87], v[100:103], v[36:39], v[72:87]
  v_cvt_pk_bf16_f32 v56, v16, v17
  v_cvt_pk_bf16_f32 v57, v18, v19
  v_cvt_pk_bf16_f32 v58, v20, v21
  v_cvt_pk_bf16_f32 v59, v22, v23
  ds_read_b128 v[36:39], v4 offset:4096
  s_waitcnt lgkmcnt(4)
  v_mfma_f32_32x32x16_bf16 v[72:87], v[104:107], v[40:43], v[72:87]
  v_cvt_pk_bf16_f32 v60, v24, v25
  v_cvt_pk_bf16_f32 v61, v26, v27
  v_cvt_pk_bf16_f32 v62, v28, v29
  v_cvt_pk_bf16_f32 v63, v30, v31
  s_barrier
  ds_read_b128 v[40:43], v5 offset:4096
  s_waitcnt lgkmcnt(4)
  v_mfma_f32_32x32x16_bf16 v[72:87], v[108:111], v[44:47], v[72:87]
  s_cmp_eq_u32 s52, 3
  s_cbranch_scc1 L_e3_6
  buffer_store_dwordx4 v[56:59], v8, s[8:11], s74 offen sc1
  buffer_store_dwordx4 v[60:63], v9, s[8:11], s74 offen sc1
  s_branch L_ee_7
L_e3_6:
  buffer_store_dwordx4 v[56:59], v8, s[16:19], s74 offen
  buffer_store_dwordx4 v[60:63], v9, s[16:19], s74 offen
L_ee_7:
  s_mov_b32 s74, s62
  s_lshl_b32 s60, s54, 1
  s_add_u32 s62, s62, s60
  ds_read_b128 v[44:47], v2 offset:8192
  s_waitcnt lgkmcnt(4)
  v_mfma_f32_32x32x16_bf16 v[72:87], v[112:115], v[48:51], v[72:87]
  s_mov_b32 m0, s59
  s_add_u32 s59, s59, 4096
  buffer_load_dwordx4 v6, s[24:27], s58 offen sc1 lds
  s_add_u32 s58, s58, 128
  ds_read_b128 v[48:51], v3 offset:8192
  s_waitcnt lgkmcnt(4)
  v_mfma_f32_32x32x16_bf16 v[72:87], v[116:119], v[32:35], v[72:87]
  ds_read_b128 v[32:35], v4 offset:8192
  s_waitcnt lgkmcnt(4)
  v_mfma_f32_32x32x16_bf16 v[72:87], v[120:123], v[36:39], v[72:87]
  s_mov_b32 m0, s59
  s_add_u32 s59, s59, 4096
  buffer_load_dwordx4 v6, s[24:27], s58 offen sc1 lds
  s_add_u32 s58, s58, 128
  ds_read_b128 v[36:39], v5 offset:8192
  s_waitcnt lgkmcnt(4)
  v_mfma_f32_32x32x16_bf16 v[72:87], v[124:127], v[40:43], v[72:87]
  ds_read_b128 v[40:43], v2 offset:12288
  s_waitcnt lgkmcnt(4)
  v_mfma_f32_32x32x16_bf16 v[72:87], v[128:131], v[44:47], v[72:87]
  s_mov_b32 m0, s59
  s_add_u32 s59, s59, 4096
  buffer_load_dwordx4 v6, s[24:27], s58 offen sc1 lds
  s_add_u32 s58, s58, 128
  ds_read_b128 v[44:47], v3 offset:12288
  s_waitcnt lgkmcnt(4)
  v_mfma_f32_32x32x16_bf16 v[72:87], v[132:135], v[48:51], v[72:87]
  s_cmp_lt_u32 s56, 3
  s_cbranch_scc0 L_ef_8
  s_waitcnt vmcnt(3)
  v_mov_b32 v12, s56
  v_mov_b32 v13, s55
  s_mov_b64 exec, 1
  buffer_store_dword v12, v13, s[8:11], 0 offen sc1
  s_mov_b64 exec, -1
L_ef_8:
  ds_read_b128 v[48:51], v4 offset:12288
  s_waitcnt lgkmcnt(4)
  v_mfma_f32_32x32x16_bf16 v[72:87], v[136:139], v[32:35], v[72:87]
  s_mov_b32 m0, s59
  s_add_u32 s59, s59, 4096
  buffer_load_dwordx4 v6, s[24:27], s58 offen sc1 lds
  s_add_u32 s58, s58, 128
  ds_read_b128 v[32:35], v5 offset:12288
  s_waitcnt lgkmcnt(4)
  v_mfma_f32_32x32x16_bf16 v[72:87], v[140:143], v[36:39], v[72:87]
  ds_read_b128 v[36:39], v2 offset:16384
  s_waitcnt lgkmcnt(4)
  v_mfma_f32_32x32x16_bf16 v[72:87], v[144:147], v[40:43], v[72:87]
  s_mov_b32 m0, s59
  s_add_u32 s59, s59, 4096
  buffer_load_dwordx4 v6, s[24:27], s58 offen sc1 lds
  s_add_u32 s58, s58, 128
  ds_read_b128 v[40:43], v3 offset:16384
  s_waitcnt lgkmcnt(4)
  v_mfma_f32_32x32x16_bf16 v[72:87], v[148:151], v[44:47], v[72:87]
  ds_read_b128 v[44:47], v4 offset:16384
  s_waitcnt lgkmcnt(4)
  v_mfma_f32_32x32x16_bf16 v[72:87], v[152:155], v[48:51], v[72:87]
  s_mov_b32 m0, s59
  s_add_u32 s59, s59, 4096
  buffer_load_dwordx4 v6, s[24:27], s58 offen sc1 lds
  s_add_u32 s58, s58, 128
  ds_read_b128 v[48:51], v5 offset:16384
  s_waitcnt lgkmcnt(4)
  v_mfma_f32_32x32x16_bf16 v[72:87], v[156:159], v[32:35], v[72:87]
  ds_read_b128 v[32:35], v2 offset:20480
  s_waitcnt lgkmcnt(4)
  v_mfma_f32_32x32x16_bf16 v[72:87], v[160:163], v[36:39], v[72:87]
  s_mov_b32 m0, s59
  s_add_u32 s59, s59, 4096
  buffer_load_dwordx4 v6, s[24:27], s58 offen sc1 lds
  s_add_u32 s58, s58, 128
  ds_read_b128 v[36:39], v3 offset:20480
  s_waitcnt lgkmcnt(4)
  v_mfma_f32_32x32x16_bf16 v[72:87], v[164:167], v[40:43], v[72:87]
  ds_read_b128 v[40:43], v4 offset:20480
  s_waitcnt lgkmcnt(4)
  v_mfma_f32_32x32x16_bf16 v[72:87], v[168:171], v[44:47], v[72:87]
  s_mov_b32 m0, s59
  s_add_u32 s59, s59, 4096
  buffer_load_dwordx4 v6, s[24:27], s58 offen sc1 lds
  s_add_u32 s58, s58, 128
  ds_read_b128 v[44:47], v5 offset:20480
  s_waitcnt lgkmcnt(4)
  v_mfma_f32_32x32x16_bf16 v[72:87], v[172:175], v[48:51], v[72:87]
  ds_read_b128 v[48:51], v2 offset:24576
  s_waitcnt lgkmcnt(4)
  v_mfma_f32_32x32x16_bf16 v[72:87], v[176:179], v[32:35], v[72:87]
  s_mov_b32 m0, s59
  s_add_u32 s59, s59, 4096
  buffer_load_dwordx4 v6, s[24:27], s58 offen sc1 lds
  s_add_u32 s58, s58, 128
  ds_read_b128 v[32:35], v3 offset:24576
  s_waitcnt lgkmcnt(4)
  v_mfma_f32_32x32x16_bf16 v[72:87], v[180:183], v[36:39], v[72:87]
  ds_read_b128 v[36:39], v4 offset:24576
  s_waitcnt lgkmcnt(4)
  v_mfma_f32_32x32x16_bf16 v[72:87], v[184:187], v[40:43], v[72:87]
  s_mov_b32 m0, s59
  s_add_u32 s59, s59, 4096
  buffer_load_dwordx4 v6, s[24:27], s58 offen sc1 lds
  s_add_u32 s58, s58, 128
  ds_read_b128 v[40:43], v5 offset:24576
  s_waitcnt lgkmcnt(4)
  v_mfma_f32_32x32x16_bf16 v[72:87], v[188:191], v[44:47], v[72:87]
  s_waitcnt vmcnt(10)
  v_mov_b32 v12, s56
  v_mov_b32 v13, s55
  s_mov_b64 exec, 1
  buffer_store_dword v12, v13, s[8:11], 0 offen sc1
  s_mov_b64 exec, -1
  ds_read_b128 v[44:47], v2 offset:28672
  s_waitcnt lgkmcnt(4)
  v_mfma_f32_32x32x16_bf16 v[72:87], v[192:195], v[48:51], v[72:87]
  ds_read_b128 v[48:51], v3 offset:28672
  s_waitcnt lgkmcnt(4)
  v_mfma_f32_32x32x16_bf16 v[72:87], v[196:199], v[32:35], v[72:87]
  ds_read_b128 v[32:35], v4 offset:28672
  s_waitcnt lgkmcnt(4)
  v_mfma_f32_32x32x16_bf16 v[72:87], v[200:203], v[36:39], v[72:87]
  s_mov_b32 exec_lo, s70
  s_mov_b32 exec_hi, 0
  buffer_load_dword v65, v64, s[24:27], s58 offen
  s_mov_b64 exec, -1
  ds_read_b128 v[36:39], v5 offset:28672
  s_waitcnt lgkmcnt(4)
  v_mfma_f32_32x32x16_bf16 v[72:87], v[204:207], v[40:43], v[72:87]
  ds_read_b128 v[40:43], v2 offset:32768
  s_waitcnt lgkmcnt(4)
  v_mfma_f32_32x32x16_bf16 v[72:87], v[208:211], v[44:47], v[72:87]
  ds_read_b128 v[44:47], v3 offset:32768
  s_waitcnt lgkmcnt(4)
  v_mfma_f32_32x32x16_bf16 v[72:87], v[212:215], v[48:51], v[72:87]
  ds_read_b128 v[48:51], v4 offset:32768
  s_waitcnt lgkmcnt(4)
  v_mfma_f32_32x32x16_bf16 v[72:87], v[216:219], v[32:35], v[72:87]
  ds_read_b128 v[32:35], v5 offset:32768
  s_waitcnt lgkmcnt(4)
  v_mfma_f32_32x32x16_bf16 v[72:87], v[220:223], v[36:39], v[72:87]
  ds_read_b128 v[36:39], v2 offset:36864
  s_waitcnt lgkmcnt(4)
  v_mfma_f32_32x32x16_bf16 v[72:87], v[224:227], v[40:43], v[72:87]
  ds_read_b128 v[40:43], v3 offset:36864
  s_waitcnt lgkmcnt(4)
  v_mfma_f32_32x32x16_bf16 v[72:87], v[228:231], v[44:47], v[72:87]
  ds_read_b128 v[44:47], v4 offset:36864
  s_waitcnt lgkmcnt(4)
  v_mfma_f32_32x32x16_bf16 v[72:87], v[232:235], v[48:51], v[72:87]
  ds_read_b128 v[48:51], v5 offset:36864
  s_waitcnt lgkmcnt(4)
  v_mfma_f32_32x32x16_bf16 v[72:87], v[236:239], v[32:35], v[72:87]
  v_add_u32 v2, s57, v2
  v_add_u32 v3, s57, v3
  v_add_u32 v4, s57, v4
  v_add_u32 v5, s57, v5
  s_sub_u32 s57, 0, s57
  s_waitcnt vmcnt(2)
  s_barrier
  ds_read_b128 v[32:35], v2 offset:0
  s_waitcnt lgkmcnt(4)
  v_mfma_f32_32x32x16_bf16 v[72:87], v[240:243], v[36:39], v[72:87]
  ds_read_b128 v[36:39], v3 offset:0
  s_waitcnt lgkmcnt(4)
  v_mfma_f32_32x32x16_bf16 v[72:87], v[244:247], v[40:43], v[72:87]
  ds_read_b128 v[40:43], v4 offset:0
  s_waitcnt lgkmcnt(4)
  v_mfma_f32_32x32x16_bf16 v[72:87], v[248:251], v[44:47], v[72:87]
  ds_read_b128 v[44:47], v5 offset:0
  s_waitcnt lgkmcnt(4)
  v_mfma_f32_32x32x16_bf16 v[72:87], v[252:255], v[48:51], v[72:87]
  s_add_u32 s56, s56, 1
  s_cmp_lt_u32 s56, s51
  s_cbranch_scc1 L_sg_no
  s_branch L_sg_endB
L_sg_sw:
  s_lshl_b32 s60, s56, 1
  s_add_u32 s60, s60, 2
  s_add_u32 s60, s60, s50
  s_add_u32 s60, s60, s63
  s_bitcmp0_b32 s56, 0
  s_cselect_b32 s59, 2, 0
  s_add_u32 s59, s59, s63
  s_mul_i32 s59, s59, 40960
  s_mul_i32 s58, s60, 40960
  s_lshl_b32 s60, s64, 10
  s_add_u32 s59, s59, s60
  ds_read_b128 v[48:51], v2 offset:4096
  s_waitcnt lgkmcnt(4)
  v_mfma_f32_32x32x16_bf16 v[16:31], v[32:35], v[96:99], 0
  ds_read_b128 v[32:35], v3 offset:4096
  s_waitcnt lgkmcnt(4)
  v_mfma_f32_32x32x16_bf16 v[16:31], v[36:39], v[100:103], v[16:31]
  v_cvt_pk_bf16_f32 v56, v72, v73
  v_cvt_pk_bf16_f32 v57, v74, v75
  v_cvt_pk_bf16_f32 v58, v76, v77
  v_cvt_pk_bf16_f32 v59, v78, v79
  ds_read_b128 v[36:39], v4 offset:4096
  s_waitcnt lgkmcnt(4)
  v_mfma_f32_32x32x16_bf16 v[16:31], v[40:43], v[104:107], v[16:31]
  v_cvt_pk_bf16_f32 v60, v80, v81
  v_cvt_pk_bf16_f32 v61, v82, v83
  v_cvt_pk_bf16_f32 v62, v84, v85
  v_cvt_pk_bf16_f32 v63, v86, v87
  s_barrier
  ds_read_b128 v[40:43], v5 offset:4096
  s_waitcnt lgkmcnt(4)
  v_mfma_f32_32x32x16_bf16 v[16:31], v[44:47], v[108:111], v[16:31]
  s_cmp_eq_u32 s52, 3
  s_cbranch_scc1 L_e3_9
  buffer_store_dwordx4 v[56:59], v8, s[8:11], s74 offen sc1
  buffer_store_dwordx4 v[60:63], v9, s[8:11], s74 offen sc1
  s_branch L_ee_10
L_e3_9:
  buffer_store_dwordx4 v[56:59], v8, s[16:19], s74 offen
  buffer_store_dwordx4 v[60:63], v9, s[16:19], s74 offen
L_ee_10:
  s_mov_b32 s74, s62
  s_lshl_b32 s60, s54, 1
  s_add_u32 s62, s62, s60
  ds_read_b128 v[44:47], v2 offset:8192
  s_waitcnt lgkmcnt(4)
  v_mfma_f32_32x32x16_bf16 v[16:31], v[48:51], v[112:115], v[16:31]
  s_mov_b32 m0, s59
  s_add_u32 s59, s59, 4096
  buffer_load_dwordx4 v6, s[24:27], s58 offen sc1 lds
  s_add_u32 s58, s58, 128
  ds_read_b128 v[48:51], v3 offset:8192
  s_waitcnt lgkmcnt(4)
  v_mfma_f32_32x32x16_bf16 v[16:31], v[32:35], v[116:119], v[16:31]
  ds_read_b128 v[32:35], v4 offset:8192
  s_waitcnt lgkmcnt(4)
  v_mfma_f32_32x32x16_bf16 v[16:31], v[36:39], v[120:123], v[16:31]
  s_mov_b32 m0, s59
  s_add_u32 s59, s59, 4096
  buffer_load_dwordx4 v6, s[24:27], s58 offen sc1 lds
  s_add_u32 s58, s58, 128
  ds_read_b128 v[36:39], v5 offset:8192
  s_waitcnt lgkmcnt(4)
  v_mfma_f32_32x32x16_bf16 v[16:31], v[40:43], v[124:127], v[16:31]
  ds_read_b128 v[40:43], v2 offset:12288
  s_waitcnt lgkmcnt(4)
  v_mfma_f32_32x32x16_bf16 v[16:31], v[44:47], v[128:131], v[16:31]
  s_mov_b32 m0, s59
  s_add_u32 s59, s59, 4096
  buffer_load_dwordx4 v6, s[24:27], s58 offen sc1 lds
  s_add_u32 s58, s58, 128
  ds_read_b128 v[44:47], v3 offset:12288
  s_waitcnt lgkmcnt(4)
  v_mfma_f32_32x32x16_bf16 v[16:31], v[48:51], v[132:135], v[16:31]
  s_cmp_lt_u32 s56, 3
  s_cbranch_scc0 L_ef_11
  s_waitcnt vmcnt(3)
  v_mov_b32 v12, s56
  v_mov_b32 v13, s55
  s_mov_b64 exec, 1
  buffer_store_dword v12, v13, s[8:11], 0 offen sc1
  s_mov_b64 exec, -1
L_ef_11:
  ds_read_b128 v[48:51], v4 offset:12288
  s_waitcnt lgkmcnt(4)
  v_mfma_f32_32x32x16_bf16 v[16:31], v[32:35], v[136:139], v[16:31]
  s_mov_b32 m0, s59
  s_add_u32 s59, s59, 4096
  buffer_load_dwordx4 v6, s[24:27], s58 offen sc1 lds
  s_add_u32 s58, s58, 128
  ds_read_b128 v[32:35], v5 offset:12288
  s_waitcnt lgkmcnt(4)
  v_mfma_f32_32x32x16_bf16 v[16:31], v[36:39], v[140:143], v[16:31]
  ds_read_b128 v[36:39], v2 offset:16384
  s_waitcnt lgkmcnt(4)
  v_mfma_f32_32x32x16_bf16 v[16:31], v[40:43], v[144:147], v[16:31]
  s_mov_b32 m0, s59
  s_add_u32 s59, s59, 4096
  buffer_load_dwordx4 v6, s[24:27], s58 offen sc1 lds
  s_add_u32 s58, s58, 128
  ds_read_b128 v[40:43], v3 offset:16384
  s_waitcnt lgkmcnt(4)
  v_mfma_f32_32x32x16_bf16 v[16:31], v[44:47], v[148:151], v[16:31]
  ds_read_b128 v[44:47], v4 offset:16384
  s_waitcnt lgkmcnt(4)
  v_mfma_f32_32x32x16_bf16 v[16:31], v[48:51], v[152:155], v[16:31]
  s_mov_b32 m0, s59
  s_add_u32 s59, s59, 4096
  buffer_load_dwordx4 v6, s[24:27], s58 offen sc1 lds
  s_add_u32 s58, s58, 128
  ds_read_b128 v[48:51], v5 offset:16384
  s_waitcnt lgkmcnt(4)
  v_mfma_f32_32x32x16_bf16 v[16:31], v[32:35], v[156:159], v[16:31]
  ds_read_b128 v[32:35], v2 offset:20480
  s_waitcnt lgkmcnt(4)
  v_mfma_f32_32x32x16_bf16 v[16:31], v[36:39], v[160:163], v[16:31]
  s_mov_b32 m0, s59
  s_add_u32 s59, s59, 4096
  buffer_load_dwordx4 v6, s[24:27], s58 offen sc1 lds
  s_add_u32 s58, s58, 128
  ds_read_b128 v[36:39], v3 offset:20480
  s_waitcnt lgkmcnt(4)
  v_mfma_f32_32x32x16_bf16 v[16:31], v[40:43], v[164:167], v[16:31]
  ds_read_b128 v[40:43], v4 offset:20480
  s_waitcnt lgkmcnt(4)
  v_mfma_f32_32x32x16_bf16 v[16:31], v[44:47], v[168:171], v[16:31]
  s_mov_b32 m0, s59
  s_add_u32 s59, s59, 4096
  buffer_load_dwordx4 v6, s[24:27], s58 offen sc1 lds
  s_add_u32 s58, s58, 128
  ds_read_b128 v[44:47], v5 offset:20480
  s_waitcnt lgkmcnt(4)
  v_mfma_f32_32x32x16_bf16 v[16:31], v[48:51], v[172:175], v[16:31]
  ds_read_b128 v[48:51], v2 offset:24576
  s_waitcnt lgkmcnt(4)
  v_mfma_f32_32x32x16_bf16 v[16:31], v[32:35], v[176:179], v[16:31]
  s_mov_b32 m0, s59
  s_add_u32 s59, s59, 4096
  buffer_load_dwordx4 v6, s[24:27], s58 offen sc1 lds
  s_add_u32 s58, s58, 128
  ds_read_b128 v[32:35], v3 offset:24576
  s_waitcnt lgkmcnt(4)
  v_mfma_f32_32x32x16_bf16 v[16:31], v[36:39], v[180:183], v[16:31]
  ds_read_b128 v[36:39], v4 offset:24576
  s_waitcnt lgkmcnt(4)
  v_mfma_f32_32x32x16_bf16 v[16:31], v[40:43], v[184:187], v[16:31]
  s_mov_b32 m0, s59
  s_add_u32 s59, s59, 4096
  buffer_load_dwordx4 v6, s[24:27], s58 offen sc1 lds
  s_add_u32 s58, s58, 128
  ds_read_b128 v[40:43], v5 offset:24576
  s_waitcnt lgkmcnt(4)
  v_mfma_f32_32x32x16_bf16 v[16:31], v[44:47], v[188:191], v[16:31]
  s_waitcnt vmcnt(10)
  v_mov_b32 v12, s56
  v_mov_b32 v13, s55
  s_mov_b64 exec, 1
  buffer_store_dword v12, v13, s[8:11], 0 offen sc1
  s_mov_b64 exec, -1
  ds_read_b128 v[44:47], v2 offset:28672
  s_waitcnt lgkmcnt(4)
  v_mfma_f32_32x32x16_bf16 v[16:31], v[48:51], v[192:195], v[16:31]
  ds_read_b128 v[48:51], v3 offset:28672
  s_waitcnt lgkmcnt(4)
  v_mfma_f32_32x32x16_bf16 v[16:31], v[32:35], v[196:199], v[16:31]
  ds_read_b128 v[32:35], v4 offset:28672
  s_waitcnt lgkmcnt(4)
  v_mfma_f32_32x32x16_bf16 v[16:31], v[36:39], v[200:203], v[16:31]
  s_mov_b32 exec_lo, s70
  s_mov_b32 exec_hi, 0
  buffer_load_dword v65, v64, s[24:27], s58 offen
  s_mov_b64 exec, -1
  ds_read_b128 v[36:39], v5 offset:28672
  s_waitcnt lgkmcnt(4)
  v_mfma_f32_32x32x16_bf16 v[16:31], v[40:43], v[204:207], v[16:31]
  ds_read_b128 v[40:43], v2 offset:32768
  s_waitcnt lgkmcnt(4)
  v_mfma_f32_32x32x16_bf16 v[16:31], v[44:47], v[208:211], v[16:31]
  ds_read_b128 v[44:47], v3 offset:32768
  s_waitcnt lgkmcnt(4)
  v_mfma_f32_32x32x16_bf16 v[16:31], v[48:51], v[212:215], v[16:31]
  ds_read_b128 v[48:51], v4 offset:32768
  s_waitcnt lgkmcnt(4)
  v_mfma_f32_32x32x16_bf16 v[16:31], v[32:35], v[216:219], v[16:31]
  ds_read_b128 v[32:35], v5 offset:32768
  s_waitcnt lgkmcnt(4)
  v_mfma_f32_32x32x16_bf16 v[16:31], v[36:39], v[220:223], v[16:31]
  ds_read_b128 v[36:39], v2 offset:36864
  s_waitcnt lgkmcnt(4)
  v_mfma_f32_32x32x16_bf16 v[16:31], v[40:43], v[224:227], v[16:31]
  ds_read_b128 v[40:43], v3 offset:36864
  s_waitcnt lgkmcnt(4)
  v_mfma_f32_32x32x16_bf16 v[16:31], v[44:47], v[228:231], v[16:31]
  ds_read_b128 v[44:47], v4 offset:36864
  s_waitcnt lgkmcnt(4)
  v_mfma_f32_32x32x16_bf16 v[16:31], v[48:51], v[232:235], v[16:31]
  ds_read_b128 v[48:51], v5 offset:36864
  s_waitcnt lgkmcnt(4)
  v_mfma_f32_32x32x16_bf16 v[16:31], v[32:35], v[236:239], v[16:31]
  v_add_u32 v2, s57, v2
  v_add_u32 v3, s57, v3
  v_add_u32 v4, s57, v4
  v_add_u32 v5, s57, v5
  s_sub_u32 s57, 0, s57
  s_waitcnt vmcnt(2)
  s_barrier
  ds_read_b128 v[32:35], v2 offset:0
  s_waitcnt lgkmcnt(4)
  v_mfma_f32_32x32x16_bf16 v[16:31], v[36:39], v[240:243], v[16:31]
  ds_read_b128 v[36:39], v3 offset:0
  s_waitcnt lgkmcnt(4)
  v_mfma_f32_32x32x16_bf16 v[16:31], v[40:43], v[244:247], v[16:31]
  ds_read_b128 v[40:43], v4 offset:0
  s_waitcnt lgkmcnt(4)
  v_mfma_f32_32x32x16_bf16 v[16:31], v[44:47], v[248:251], v[16:31]
  ds_read_b128 v[44:47], v5 offset:0
  s_waitcnt lgkmcnt(4)
  v_mfma_f32_32x32x16_bf16 v[16:31], v[48:51], v[252:255], v[16:31]
  s_add_u32 s56, s56, 1
  s_cmp_lt_u32 s56, s51
  s_cbranch_scc0 L_sg_endA
  s_lshl_b32 s60, s56, 1
  s_add_u32 s60, s60, 2
  s_add_u32 s60, s60, s50
  s_add_u32 s60, s60, s63
  s_bitcmp0_b32 s56, 0
  s_cselect_b32 s59, 2, 0
  s_add_u32 s59, s59, s63
  s_mul_i32 s59, s59, 40960
  s_mul_i32 s58, s60, 40960
  s_lshl_b32 s60, s64, 10
  s_add_u32 s59, s59, s60
  ds_read_b128 v[48:51], v2 offset:4096
  s_waitcnt lgkmcnt(4)
  v_mfma_f32_32x32x16_bf16 v[72:87], v[32:35], v[96:99], 0
  ds_read_b128 v[32:35], v3 offset:4096
  s_waitcnt lgkmcnt(4)
  v_mfma_f32_32x32x16_bf16 v[72:87], v[36:39], v[100:103], v[72:87]
  v_cvt_pk_bf16_f32 v56, v16, v17
  v_cvt_pk_bf16_f32 v57, v18, v19
  v_cvt_pk_bf16_f32 v58, v20, v21
  v_cvt_pk_bf16_f32 v59, v22, v23
  ds_read_b128 v[36:39], v4 offset:4096
  s_waitcnt lgkmcnt(4)
  v_mfma_f32_32x32x16_bf16 v[72:87], v[40:43], v[104:107], v[72:87]
  v_cvt_pk_bf16_f32 v60, v24, v25
  v_cvt_pk_bf16_f32 v61, v26, v27
  v_cvt_pk_bf16_f32 v62, v28, v29
  v_cvt_pk_bf16_f32 v63, v30, v31
  s_barrier
  ds_read_b128 v[40:43], v5 offset:4096
  s_waitcnt lgkmcnt(4)
  v_mfma_f32_32x32x16_bf16 v[72:87], v[44:47], v[108:111], v[72:87]
  s_cmp_eq_u32 s52, 3
  s_cbranch_scc1 L_e3_12
  buffer_store_dwordx4 v[56:59], v8, s[8:11], s74 offen sc1
  buffer_store_dwordx4 v[60:63], v9, s[8:11], s74 offen sc1
  s_branch L_ee_13
L_e3_12:
  buffer_store_dwordx4 v[56:59], v8, s[16:19], s74 offen
  buffer_store_dwordx4 v[60:63], v9, s[16:19], s74 offen
L_ee_13:
  s_mov_b32 s74, s62
  s_lshl_b32 s60, s54, 1
  s_add_u32 s62, s62, s60
  ds_read_b128 v[44:47], v2 offset:8192
  s_waitcnt lgkmcnt(4)
  v_mfma_f32_32x32x16_bf16 v[72:87], v[48:51], v[112:115], v[72:87]
  s_mov_b32 m0, s59
  s_add_u32 s59, s59, 4096
  buffer_load_dwordx4 v6, s[24:27], s58 offen sc1 lds
  s_add_u32 s58, s58, 128
  ds_read_b128 v[48:51], v3 offset:8192
  s_waitcnt lgkmcnt(4)
  v_mfma_f32_32x32x16_bf16 v[72:87], v[32:35], v[116:119], v[72:87]
  ds_read_b128 v[32:35], v4 offset:8192
  s_waitcnt lgkmcnt(4)
  v_mfma_f32_32x32x16_bf16 v[72:87], v[36:39], v[120:123], v[72:87]
  s_mov_b32 m0, s59
  s_add_u32 s59, s59, 4096
  buffer_load_dwordx4 v6, s[24:27], s58 offen sc1 lds
  s_add_u32 s58, s58, 128
  ds_read_b128 v[36:39], v5 offset:8192
  s_waitcnt lgkmcnt(4)
  v_mfma_f32_32x32x16_bf16 v[72:87], v[40:43], v[124:127], v[72:87]
  ds_read_b128 v[40:43], v2 offset:12288
  s_waitcnt lgkmcnt(4)
  v_mfma_f32_32x32x16_bf16 v[72:87], v[44:47], v[128:131], v[72:87]
  s_mov_b32 m0, s59
  s_add_u32 s59, s59, 4096
  buffer_load_dwordx4 v6, s[24:27], s58 offen sc1 lds
  s_add_u32 s58, s58, 128
  ds_read_b128 v[44:47], v3 offset:12288
  s_waitcnt lgkmcnt(4)
  v_mfma_f32_32x32x16_bf16 v[72:87], v[48:51], v[132:135], v[72:87]
  s_cmp_lt_u32 s56, 3
  s_cbranch_scc0 L_ef_14
  s_waitcnt vmcnt(3)
  v_mov_b32 v12, s56
  v_mov_b32 v13, s55
  s_mov_b64 exec, 1
  buffer_store_dword v12, v13, s[8:11], 0 offen sc1
  s_mov_b64 exec, -1
L_ef_14:
  ds_read_b128 v[48:51], v4 offset:12288
  s_waitcnt lgkmcnt(4)
  v_mfma_f32_32x32x16_bf16 v[72:87], v[32:35], v[136:139], v[72:87]
  s_mov_b32 m0, s59
  s_add_u32 s59, s59, 4096
  buffer_load_dwordx4 v6, s[24:27], s58 offen sc1 lds
  s_add_u32 s58, s58, 128
  ds_read_b128 v[32:35], v5 offset:12288
  s_waitcnt lgkmcnt(4)
  v_mfma_f32_32x32x16_bf16 v[72:87], v[36:39], v[140:143], v[72:87]
  ds_read_b128 v[36:39], v2 offset:16384
  s_waitcnt lgkmcnt(4)
  v_mfma_f32_32x32x16_bf16 v[72:87], v[40:43], v[144:147], v[72:87]
  s_mov_b32 m0, s59
  s_add_u32 s59, s59, 4096
  buffer_load_dwordx4 v6, s[24:27], s58 offen sc1 lds
  s_add_u32 s58, s58, 128
  ds_read_b128 v[40:43], v3 offset:16384
  s_waitcnt lgkmcnt(4)
  v_mfma_f32_32x32x16_bf16 v[72:87], v[44:47], v[148:151], v[72:87]
  ds_read_b128 v[44:47], v4 offset:16384
  s_waitcnt lgkmcnt(4)
  v_mfma_f32_32x32x16_bf16 v[72:87], v[48:51], v[152:155], v[72:87]
  s_mov_b32 m0, s59
  s_add_u32 s59, s59, 4096
  buffer_load_dwordx4 v6, s[24:27], s58 offen sc1 lds
  s_add_u32 s58, s58, 128
  ds_read_b128 v[48:51], v5 offset:16384
  s_waitcnt lgkmcnt(4)
  v_mfma_f32_32x32x16_bf16 v[72:87], v[32:35], v[156:159], v[72:87]
  ds_read_b128 v[32:35], v2 offset:20480
  s_waitcnt lgkmcnt(4)
  v_mfma_f32_32x32x16_bf16 v[72:87], v[36:39], v[160:163], v[72:87]
  s_mov_b32 m0, s59
  s_add_u32 s59, s59, 4096
  buffer_load_dwordx4 v6, s[24:27], s58 offen sc1 lds
  s_add_u32 s58, s58, 128
  ds_read_b128 v[36:39], v3 offset:20480
  s_waitcnt lgkmcnt(4)
  v_mfma_f32_32x32x16_bf16 v[72:87], v[40:43], v[164:167], v[72:87]
  ds_read_b128 v[40:43], v4 offset:20480
  s_waitcnt lgkmcnt(4)
  v_mfma_f32_32x32x16_bf16 v[72:87], v[44:47], v[168:171], v[72:87]
  s_mov_b32 m0, s59
  s_add_u32 s59, s59, 4096
  buffer_load_dwordx4 v6, s[24:27], s58 offen sc1 lds
  s_add_u32 s58, s58, 128
  ds_read_b128 v[44:47], v5 offset:20480
  s_waitcnt lgkmcnt(4)
  v_mfma_f32_32x32x16_bf16 v[72:87], v[48:51], v[172:175], v[72:87]
  ds_read_b128 v[48:51], v2 offset:24576
  s_waitcnt lgkmcnt(4)
  v_mfma_f32_32x32x16_bf16 v[72:87], v[32:35], v[176:179], v[72:87]
  s_mov_b32 m0, s59
  s_add_u32 s59, s59, 4096
  buffer_load_dwordx4 v6, s[24:27], s58 offen sc1 lds
  s_add_u32 s58, s58, 128
  ds_read_b128 v[32:35], v3 offset:24576
  s_waitcnt lgkmcnt(4)
  v_mfma_f32_32x32x16_bf16 v[72:87], v[36:39], v[180:183], v[72:87]
  ds_read_b128 v[36:39], v4 offset:24576
  s_waitcnt lgkmcnt(4)
  v_mfma_f32_32x32x16_bf16 v[72:87], v[40:43], v[184:187], v[72:87]
  s_mov_b32 m0, s59
  s_add_u32 s59, s59, 4096
  buffer_load_dwordx4 v6, s[24:27], s58 offen sc1 lds
  s_add_u32 s58, s58, 128
  ds_read_b128 v[40:43], v5 offset:24576
  s_waitcnt lgkmcnt(4)
  v_mfma_f32_32x32x16_bf16 v[72:87], v[44:47], v[188:191], v[72:87]
  s_waitcnt vmcnt(10)
  v_mov_b32 v12, s56
  v_mov_b32 v13, s55
  s_mov_b64 exec, 1
  buffer_store_dword v12, v13, s[8:11], 0 offen sc1
  s_mov_b64 exec, -1
  ds_read_b128 v[44:47], v2 offset:28672
  s_waitcnt lgkmcnt(4)
  v_mfma_f32_32x32x16_bf16 v[72:87], v[48:51], v[192:195], v[72:87]
  ds_read_b128 v[48:51], v3 offset:28672
  s_waitcnt lgkmcnt(4)
  v_mfma_f32_32x32x16_bf16 v[72:87], v[32:35], v[196:199], v[72:87]
  ds_read_b128 v[32:35], v4 offset:28672
  s_waitcnt lgkmcnt(4)
  v_mfma_f32_32x32x16_bf16 v[72:87], v[36:39], v[200:203], v[72:87]
  s_mov_b32 exec_lo, s70
  s_mov_b32 exec_hi, 0
  buffer_load_dword v65, v64, s[24:27], s58 offen
  s_mov_b64 exec, -1
  ds_read_b128 v[36:39], v5 offset:28672
  s_waitcnt lgkmcnt(4)
  v_mfma_f32_32x32x16_bf16 v[72:87], v[40:43], v[204:207], v[72:87]
  ds_read_b128 v[40:43], v2 offset:32768
  s_waitcnt lgkmcnt(4)
  v_mfma_f32_32x32x16_bf16 v[72:87], v[44:47], v[208:211], v[72:87]
  ds_read_b128 v[44:47], v3 offset:32768
  s_waitcnt lgkmcnt(4)
  v_mfma_f32_32x32x16_bf16 v[72:87], v[48:51], v[212:215], v[72:87]
  ds_read_b128 v[48:51], v4 offset:32768
  s_waitcnt lgkmcnt(4)
  v_mfma_f32_32x32x16_bf16 v[72:87], v[32:35], v[216:219], v[72:87]
  ds_read_b128 v[32:35], v5 offset:32768
  s_waitcnt lgkmcnt(4)
  v_mfma_f32_32x32x16_bf16 v[72:87], v[36:39], v[220:223], v[72:87]
  ds_read_b128 v[36:39], v2 offset:36864
  s_waitcnt lgkmcnt(4)
  v_mfma_f32_32x32x16_bf16 v[72:87], v[40:43], v[224:227], v[72:87]
  ds_read_b128 v[40:43], v3 offset:36864
  s_waitcnt lgkmcnt(4)
  v_mfma_f32_32x32x16_bf16 v[72:87], v[44:47], v[228:231], v[72:87]
  ds_read_b128 v[44:47], v4 offset:36864
  s_waitcnt lgkmcnt(4)
  v_mfma_f32_32x32x16_bf16 v[72:87], v[48:51], v[232:235], v[72:87]
  ds_read_b128 v[48:51], v5 offset:36864
  s_waitcnt lgkmcnt(4)
  v_mfma_f32_32x32x16_bf16 v[72:87], v[32:35], v[236:239], v[72:87]
  v_add_u32 v2, s57, v2
  v_add_u32 v3, s57, v3
  v_add_u32 v4, s57, v4
  v_add_u32 v5, s57, v5
  s_sub_u32 s57, 0, s57
  s_waitcnt vmcnt(2)
  s_barrier
  ds_read_b128 v[32:35], v2 offset:0
  s_waitcnt lgkmcnt(4)
  v_mfma_f32_32x32x16_bf16 v[72:87], v[36:39], v[240:243], v[72:87]
  ds_read_b128 v[36:39], v3 offset:0
  s_waitcnt lgkmcnt(4)
  v_mfma_f32_32x32x16_bf16 v[72:87], v[40:43], v[244:247], v[72:87]
  ds_read_b128 v[40:43], v4 offset:0
  s_waitcnt lgkmcnt(4)
  v_mfma_f32_32x32x16_bf16 v[72:87], v[44:47], v[248:251], v[72:87]
  ds_read_b128 v[44:47], v5 offset:0
  s_waitcnt lgkmcnt(4)
  v_mfma_f32_32x32x16_bf16 v[72:87], v[48:51], v[252:255], v[72:87]
  s_add_u32 s56, s56, 1
  s_cmp_lt_u32 s56, s51
  s_cbranch_scc1 L_sg_sw
  s_branch L_sg_endB
L_sg_endA:
  s_nop 8
  v_cvt_pk_bf16_f32 v56, v16, v17
  v_cvt_pk_bf16_f32 v57, v18, v19
  v_cvt_pk_bf16_f32 v58, v20, v21
  v_cvt_pk_bf16_f32 v59, v22, v23
  v_cvt_pk_bf16_f32 v60, v24, v25
  v_cvt_pk_bf16_f32 v61, v26, v27
  v_cvt_pk_bf16_f32 v62, v28, v29
  v_cvt_pk_bf16_f32 v63, v30, v31
  s_branch L_sg_fin
L_sg_endB:
  s_nop 7
  v_cvt_pk_bf16_f32 v56, v72, v73
  v_cvt_pk_bf16_f32 v57, v74, v75
  v_cvt_pk_bf16_f32 v58, v76, v77
  v_cvt_pk_bf16_f32 v59, v78, v79
  v_cvt_pk_bf16_f32 v60, v80, v81
  v_cvt_pk_bf16_f32 v61, v82, v83
  v_cvt_pk_bf16_f32 v62, v84, v85
  v_cvt_pk_bf16_f32 v63, v86, v87
L_sg_fin:
  s_cmp_eq_u32 s52, 3
  s_cbranch_scc1 L_e3_15
  buffer_store_dwordx4 v[56:59], v8, s[8:11], s74 offen sc1
  buffer_store_dwordx4 v[60:63], v9, s[8:11], s74 offen sc1
  s_branch L_ee_16
L_e3_15:
  buffer_store_dwordx4 v[56:59], v8, s[16:19], s74 offen
  buffer_store_dwordx4 v[60:63], v9, s[16:19], s74 offen
L_ee_16:
  s_waitcnt vmcnt(0) lgkmcnt(0)
  v_mov_b32 v12, s56
  v_mov_b32 v13, s55
  s_mov_b64 exec, 1
  buffer_store_dword v12, v13, s[8:11], 0 offen sc1
  s_mov_b64 exec, -1
  s_cmp_eq_u32 s47, 1
  s_cbranch_scc1 L_b_A4
  s_cmp_lt_u32 s46, 96
  s_cbranch_scc0 L_b_A2
  s_cmp_lt_u32 s46, 80
  s_cbranch_scc0 L_b_T
  s_cmp_eq_u32 s3, 0
  s_cbranch_scc0 L_cd_18
  v_mov_b32 v12, 0x281100
  s_mov_b32 s66, 524288
L_cw_17:
  buffer_load_dword v13, v12, s[8:11], 0 offen sc1
  s_waitcnt vmcnt(0)
  v_readfirstlane_b32 s6, v13
  s_cmp_ge_u32 s6, 32
  s_cbranch_scc1 L_cd_18
  s_sleep 10
  s_sub_u32 s66, s66, 1
  s_cmp_lg_u32 s66, 0
  s_cbranch_scc1 L_cw_17
  s_endpgm
L_cd_18:
  s_barrier
  s_mov_b32 s47, 1
  s_mov_b32 s20, s32
  s_mov_b32 s21, s33
  s_mov_b32 s22, 0xc8000
  s_mov_b32 s23, 0x20000
  s_add_u32 s24, s8, 0x9c00000
  s_addc_u32 s25, s9, 0
  s_mov_b32 s26, 0x280000
  s_mov_b32 s27, 0x20000
  s_mul_i32 s7, s46, 205
  s_lshr_b32 s7, s7, 10
  s_mul_i32 s6, s7, 5
  s_sub_u32 s6, s46, s6
  s_lshl_b32 s48, s6, 8
  s_mov_b32 s49, 1280
  s_lshl_b32 s50, s7, 2
  s_mov_b32 s51, 2
  s_mov_b32 s52, 3
  s_mov_b32 s68, 0
  s_mov_b32 s69, 0
  s_mov_b32 s70, 1
  s_mov_b32 s54, 81920
  s_mul_i32 s53, s50, 81920
  s_add_u32 s53, s53, s48
  s_and_b32 s6, s3, 3
  s_lshl_b32 s6, s6, 6
  v_and_b32 v12, 31, v1
  v_mul_u32_u24 v12, 2560, v12
  v_lshrrev_b32 v13, 5, v1
  v_lshl_add_u32 v12, v13, 4, v12
  v_add_u32 v8, s6, v12
  v_add_u32 v9, 32, v8
  s_lshl_b32 s55, s46, 3
  s_add_u32 s55, s55, s3
  s_lshl_b32 s55, s55, 2
  s_add_u32 s55, s55, 0x282000
  s_branch L_b_sg
L_b_A2:
  s_waitcnt vmcnt(0)
  s_barrier
  s_cmp_eq_u32 s3, 0
  s_cbranch_scc0 L_ca_19
  v_mov_b32 v12, 0x281000
  v_mov_b32 v13, 1
  s_mov_b64 exec, 1
  buffer_atomic_add v13, v12, s[8:11], 0 offen sc1
  s_mov_b64 exec, -1
L_ca_19:
  s_branch L_b_A2b
L_b_idle:
  s_cmp_eq_u32 s3, 0
  s_cbranch_scc0 L_cal_end
  s_getreg_b32 s49, hwreg(HW_REG_XCC_ID, 0, 3)
  v_and_b32 v2, 1, v1
  v_lshlrev_b32 v2, 13, v2
  v_lshrrev_b32 v3, 1, v1
  v_lshl_add_u32 v2, v3, 8, v2
  s_and_b32 s48, s46, 1
  s_lshl_b32 s48, s48, 14
  s_add_u32 s48, s48, 0x8580000
  buffer_store_dword v1, v2, s[8:11], s48 offen sc1
  s_waitcnt vmcnt(0)
  s_mov_b32 s50, -1
  s_mov_b32 s51, -1
  s_mov_b64 s[56:57], 1
  s_mov_b32 s58, 7
L_cal_lp:
  s_mov_b64 exec, s[56:57]
  s_memtime s[52:53]
  s_waitcnt lgkmcnt(0)
  buffer_load_dword v3, v2, s[8:11], s48 offen sc1
  s_waitcnt vmcnt(0)
  s_memtime s[54:55]
  s_lshl_b64 s[56:57], s[56:57], 1
  s_waitcnt lgkmcnt(0)
  s_sub_u32 s54, s54, s52
  s_min_u32 s50, s50, s54
  s_mov_b64 exec, s[56:57]
  s_memtime s[52:53]
  s_waitcnt lgkmcnt(0)
  buffer_load_dword v3, v2, s[8:11], s48 offen sc1
  s_waitcnt vmcnt(0)
  s_memtime s[54:55]
  s_lshl_b64 s[56:57], s[56:57], 1
  s_waitcnt lgkmcnt(0)
  s_sub_u32 s54, s54, s52
  s_min_u32 s51, s51, s54
  s_sub_u32 s58, s58, 1
  s_cmp_lg_u32 s58, 0
  s_cbranch_scc1 L_cal_lp
  s_sub_i32 s50, s50, s51
  s_sub_i32 s51, 0, s50
  s_cmp_lt_u32 s49, 4
  s_cselect_b32 s50, s50, s51
  s_mov_b64 exec, 1
  v_mov_b32 v2, 8
  v_mov_b32 v3, s50
  buffer_atomic_add v3, v2, s[12:15], 0 offen
  s_waitcnt vmcnt(0)
  v_mov_b32 v2, 16
  v_mov_b32 v4, 1
  buffer_atomic_add v4, v2, s[12:15], 0 offen
  s_mov_b64 exec, -1
L_cal_end:
  v_lshlrev_b32 v12, 5, v1
  s_mov_b32 s62, 65536
L_rdy_20:
  buffer_load_dword v13, v12, s[12:15], 0 offen offset:4 sc1
  s_waitcnt vmcnt(0)
  v_readlane_b32 s60, v13, 0
  v_readlane_b32 s61, v13, 1
  s_add_u32 s60, s60, s61
  v_readlane_b32 s61, v13, 2
  s_add_u32 s60, s60, s61
  v_readlane_b32 s61, v13, 3
  s_add_u32 s60, s60, s61
  v_readlane_b32 s61, v13, 4
  s_add_u32 s60, s60, s61
  v_readlane_b32 s61, v13, 5
  s_add_u32 s60, s60, s61
  v_readlane_b32 s61, v13, 6
  s_add_u32 s60, s60, s61
  v_readlane_b32 s61, v13, 7
  s_add_u32 s60, s60, s61
  s_cmp_ge_u32 s60, 256
  s_cbranch_scc1 L_rdyd_21
  s_sleep 8
  s_sub_u32 s62, s62, 1
  s_cmp_lg_u32 s62, 0
  s_cbranch_scc1 L_rdy_20
  s_endpgm
L_rdyd_21:
L_b_A2b:
  s_cmp_eq_u32 s3, 0
  s_cbranch_scc0 L_cd_23
  v_mov_b32 v12, 0x281000
  s_mov_b32 s66, 524288
L_cw_22:
  buffer_load_dword v13, v12, s[8:11], 0 offen sc1
  s_waitcnt vmcnt(0)
  v_readfirstlane_b32 s6, v13
  s_cmp_ge_u32 s6, 30
  s_cbranch_scc1 L_cd_23
  s_sleep 10
  s_sub_u32 s66, s66, 1
  s_cmp_lg_u32 s66, 0
  s_cbranch_scc1 L_cw_22
  s_endpgm
L_cd_23:
  s_barrier
  s_sub_u32 s6, s46, 96
  s_lshr_b32 s7, s6, 1
  s_mul_i32 s7, s7, 163840
  s_add_u32 s49, s7, 0x9400000
  s_and_b32 s51, s6, 1
  s_mul_i32 s50, s51, 98304
  s_lshl_b32 s51, s51, 3
  s_add_u32 s51, s51, 65536
  v_lshlrev_b32 v9, 4, v1
  v_and_b32 v12, 31, v1
  v_lshrrev_b32 v13, 5, v1
  v_lshlrev_b32 v14, 15, v13
  v_lshl_add_u32 v2, v12, 4, v14
  v_add_u32 v11, s50, v2
  v_lshlrev_b32 v3, 4, v12
  v_add_u32 v3, s51, v3
  s_add_u32 s7, s49, s51
  v_mov_b32 v14, 0x7fffff00
  s_mov_b32 exec_lo, 0
  v_mov_b32 v3, v14
  s_mov_b64 exec, -1
  v_mul_u32_u24 v14, 1280, v12
  v_lshl_add_u32 v14, v13, 3, v14
  s_mul_i32 s51, s6, 40
  v_add_u32 v6, s51, v14
  s_add_u32 s51, s49, s50
  s_add_u32 s51, s51, 2621440
  s_lshl_b32 s50, s3, 13
  s_add_u32 s51, s51, s50
  s_add_u32 m0, s50, 0
  s_nop 0
  buffer_load_dwordx4 v9, s[8:11], s51 offen offset:0 sc1 lds
  buffer_load_dwordx4 v9, s[8:11], s51 offen offset:1024 sc1 lds
  buffer_load_dwordx4 v9, s[8:11], s51 offen offset:2048 sc1 lds
  buffer_load_dwordx4 v9, s[8:11], s51 offen offset:3072 sc1 lds
  s_add_u32 m0, s50, 4096
  s_add_u32 s51, s51, 4096
  buffer_load_dwordx4 v9, s[8:11], s51 offen offset:0 sc1 lds
  buffer_load_dwordx4 v9, s[8:11], s51 offen offset:1024 sc1 lds
  buffer_load_dwordx4 v9, s[8:11], s51 offen offset:2048 sc1 lds
  buffer_load_dwordx4 v9, s[8:11], s51 offen offset:3072 sc1 lds
  s_mul_i32 s51, s6, 81920
  s_mul_i32 s50, s3, 10240
  s_add_u32 s51, s51, s50
  s_add_u32 s51, s51, 0x9900000
  s_add_u32 m0, s50, 81920
  s_nop 0
  buffer_load_dwordx4 v9, s[8:11], s51 offen offset:0 sc1 lds
  buffer_load_dwordx4 v9, s[8:11], s51 offen offset:1024 sc1 lds
  buffer_load_dwordx4 v9, s[8:11], s51 offen offset:2048 sc1 lds
  buffer_load_dwordx4 v9, s[8:11], s51 offen offset:3072 sc1 lds
  s_add_u32 m0, s50, 86016
  s_add_u32 s51, s51, 4096
  buffer_load_dwordx4 v9, s[8:11], s51 offen offset:0 sc1 lds
  buffer_load_dwordx4 v9, s[8:11], s51 offen offset:1024 sc1 lds
  buffer_load_dwordx4 v9, s[8:11], s51 offen offset:2048 sc1 lds
  buffer_load_dwordx4 v9, s[8:11], s51 offen offset:3072 sc1 lds
  s_add_u32 m0, s50, 90112
  s_add_u32 s51, s51, 4096
  buffer_load_dwordx4 v9, s[8:11], s51 offen offset:0 sc1 lds
  buffer_load_dwordx4 v9, s[8:11], s51 offen offset:1024 sc1 lds
  s_lshl_b32 s50, s3, 12
  s_add_u32 s7, s7, s50
  s_add_u32 s7, s7, 2621440
  buffer_load_dwordx2 v[32:33], v9, s[8:11], s7 offen offset:0 sc1
  buffer_load_dwordx2 v[34:35], v9, s[8:11], s7 offen offset:1024 sc1
  buffer_load_dwordx2 v[36:37], v9, s[8:11], s7 offen offset:2048 sc1
  buffer_load_dwordx2 v[38:39], v9, s[8:11], s7 offen offset:3072 sc1
  s_mov_b32 s48, s3
  s_lshl_b32 s51, s48, 9
  s_add_u32 s51, s51, s49
  buffer_load_dwordx4 v[216:219], v11, s[8:11], s51 offen sc1
  buffer_load_dwordx2 v[220:221], v3, s[8:11], s51 offen sc1
  s_lshl_b32 s50, s3, 11
  v_lshlrev_b32 v14, 3, v1
  v_add_u32 v14, s50, v14
  v_add_u32 v14, 65536, v14
  s_mov_b32 s52, 0x3ea52b5c
  s_mov_b32 s53, 0xbea52b5c
  v_lshlrev_b32 v15, 2, v13
  v_sub_u32 v15, v12, v15
  v_cmp_le_i32 s[68:69], 0, v15
  v_cmp_le_i32 s[70:71], 1, v15
  v_cmp_le_i32 s[72:73], 2, v15
  v_cmp_le_i32 s[74:75], 3, v15
  v_cmp_le_i32 s[76:77], 8, v15
  v_cmp_le_i32 s[78:79], 9, v15
  v_cmp_le_i32 s[80:81], 10, v15
  v_cmp_le_i32 s[82:83], 11, v15
  v_cmp_le_i32 s[84:85], 16, v15
  v_cmp_le_i32 s[86:87], 17, v15
  v_cmp_le_i32 s[88:89], 18, v15
  v_cmp_le_i32 s[90:91], 19, v15
  v_cmp_le_i32 s[92:93], 24, v15
  v_cmp_le_i32 s[94:95], 25, v15
  v_cmp_le_i32 s[96:97], 26, v15
  v_cmp_le_i32 s[98:99], 27, v15
  v_mul_u32_u24 v7, 320, v13
  v_lshl_add_u32 v7, v12, 4, v7
  v_lshlrev_b32 v8, 3, v12
  v_mov_b32 v15, 0xff800000
  v_mov_b32 v12, 0
  v_mov_b32 v13, 0x3f803f80
  s_mov_b32 s6, 0x00100000
  s_mov_b32 s7, 0x00100000
  v_cndmask_b32 v12, v12, v13, s[6:7]
  v_mov_b32 v192, v12
  v_mov_b32 v176, 0
  v_mov_b32 v193, v12
  v_mov_b32 v177, 0
  v_mov_b32 v194, v12
  v_mov_b32 v178, 0
  v_mov_b32 v195, v12
  v_mov_b32 v179, 0
  v_mov_b32 v196, v12
  v_mov_b32 v180, 0
  v_mov_b32 v197, v12
  v_mov_b32 v181, 0
  v_mov_b32 v198, v12
  v_mov_b32 v182, 0
  v_mov_b32 v199, v12
  v_mov_b32 v183, 0
  v_mov_b32 v200, v12
  v_mov_b32 v184, 0
  v_mov_b32 v201, v12
  v_mov_b32 v185, 0
  v_mov_b32 v202, v12
  v_mov_b32 v186, 0
  v_mov_b32 v203, v12
  v_mov_b32 v187, 0
  v_mov_b32 v204, v12
  v_mov_b32 v188, 0
  v_mov_b32 v205, v12
  v_mov_b32 v189, 0
  v_mov_b32 v206, v12
  v_mov_b32 v190, 0
  v_mov_b32 v207, v12
  v_mov_b32 v191, 0
  v_mov_b32 v214, 0
  v_mov_b32 v215, 0
  s_waitcnt vmcnt(2)
  ds_write_b64 v14, v[32:33] offset:0
  ds_write_b64 v14, v[34:35] offset:512
  ds_write_b64 v14, v[36:37] offset:1024
  ds_write_b64 v14, v[38:39] offset:1536
  s_waitcnt vmcnt(0) lgkmcnt(0)
  s_barrier
L_a2_top:
  s_sub_i32 s50, s48, 8
  s_max_i32 s50, s50, 0
  s_lshl_b32 s6, s50, 9
  v_add_u32 v4, s6, v2
  s_lshl_b32 s6, s50, 8
  s_add_u32 s6, s6, 65536
  v_add_u32 v5, s6, v8
  s_mul_i32 s6, s50, 1280
  s_add_u32 s6, s6, 81920
  v_add_u32 v10, s6, v7
  s_waitcnt vmcnt(3)
  v_mov_b32 v208, v216
  v_mov_b32 v209, v217
  v_mov_b32 v210, v218
  v_mov_b32 v211, v219
  v_mov_b32 v212, v220
  v_mov_b32 v213, v221
  s_add_u32 s6, s48, 8
  s_lshl_b32 s51, s6, 9
  s_add_u32 s51, s51, s49
  buffer_load_dwordx4 v[216:219], v11, s[8:11], s51 offen sc1
  buffer_load_dwordx2 v[220:221], v3, s[8:11], s51 offen sc1
  s_min_u32 s51, s48, 8
  ds_read_b128 v[176:179], v4 offset:0
  s_mov_b32 exec_hi, 0
  ds_read_b64 v[180:181], v5 offset:0
  s_mov_b32 exec_hi, -1
  ds_read_b128 v[184:187], v4 offset:512
  s_mov_b32 exec_hi, 0
  ds_read_b64 v[188:189], v5 offset:256
  s_mov_b32 exec_hi, -1
  s_waitcnt lgkmcnt(2)
  v_mfma_f32_32x32x16_bf16 v[32:47], v[176:179], v[208:211], 0
  v_mfma_f32_32x32x16_bf16 v[32:47], v[180:183], v[212:215], v[32:47]
  ds_read_b128 v[176:179], v4 offset:1024
  s_mov_b32 exec_hi, 0
  ds_read_b64 v[180:181], v5 offset:512
  s_mov_b32 exec_hi, -1
  s_waitcnt lgkmcnt(2)
  v_mfma_f32_32x32x16_bf16 v[48:63], v[184:187], v[208:211], 0
  v_mfma_f32_32x32x16_bf16 v[48:63], v[188:191], v[212:215], v[48:63]
  ds_read_b128 v[184:187], v4 offset:1536
  s_mov_b32 exec_hi, 0
  ds_read_b64 v[188:189], v5 offset:768
  s_mov_b32 exec_hi, -1
  s_waitcnt lgkmcnt(2)
  v_mfma_f32_32x32x16_bf16 v[64:79], v[176:179], v[208:211], 0
  v_mfma_f32_32x32x16_bf16 v[64:79], v[180:183], v[212:215], v[64:79]
  ds_read_b128 v[176:179], v4 offset:2048
  s_mov_b32 exec_hi, 0
  ds_read_b64 v[180:181], v5 offset:1024
  s_mov_b32 exec_hi, -1
  s_waitcnt lgkmcnt(2)
  v_mfma_f32_32x32x16_bf16 v[80:95], v[184:187], v[208:211], 0
  v_mfma_f32_32x32x16_bf16 v[80:95], v[188:191], v[212:215], v[80:95]
  ds_read_b128 v[184:187], v4 offset:2560
  s_mov_b32 exec_hi, 0
  ds_read_b64 v[188:189], v5 offset:1280
  s_mov_b32 exec_hi, -1
  s_waitcnt lgkmcnt(2)
  v_mfma_f32_32x32x16_bf16 v[96:111], v[176:179], v[208:211], 0
  v_mfma_f32_32x32x16_bf16 v[96:111], v[180:183], v[212:215], v[96:111]
  ds_read_b128 v[176:179], v4 offset:3072
  s_mov_b32 exec_hi, 0
  ds_read_b64 v[180:181], v5 offset:1536
  s_mov_b32 exec_hi, -1
  s_waitcnt lgkmcnt(2)
  v_mfma_f32_32x32x16_bf16 v[112:127], v[184:187], v[208:211], 0
  v_mfma_f32_32x32x16_bf16 v[112:127], v[188:191], v[212:215], v[112:127]
  ds_read_b128 v[184:187], v4 offset:3584
  s_mov_b32 exec_hi, 0
  ds_read_b64 v[188:189], v5 offset:1792
  s_mov_b32 exec_hi, -1
  s_waitcnt lgkmcnt(2)
  v_mfma_f32_32x32x16_bf16 v[128:143], v[176:179], v[208:211], 0
  v_mfma_f32_32x32x16_bf16 v[128:143], v[180:183], v[212:215], v[128:143]
  ds_read_b128 v[176:179], v4 offset:4096
  s_mov_b32 exec_hi, 0
  ds_read_b64 v[180:181], v5 offset:2048
  s_mov_b32 exec_hi, -1
  s_waitcnt lgkmcnt(2)
  v_mfma_f32_32x32x16_bf16 v[144:159], v[184:187], v[208:211], 0
  v_mfma_f32_32x32x16_bf16 v[144:159], v[188:191], v[212:215], v[144:159]
  s_waitcnt lgkmcnt(0)
  v_mfma_f32_32x32x16_bf16 v[160:175], v[176:179], v[208:211], 0
  v_mfma_f32_32x32x16_bf16 v[160:175], v[180:183], v[212:215], v[160:175]
  s_cmp_lt_u32 s48, 8
  s_cbranch_scc1 L_a2_head
  v_cndmask_b32 v32, v32, v15, s[68:69]
  v_cndmask_b32 v33, v33, v15, s[70:71]
  v_cndmask_b32 v34, v34, v15, s[72:73]
  v_cndmask_b32 v35, v35, v15, s[74:75]
  v_cndmask_b32 v36, v36, v15, s[76:77]
  v_cndmask_b32 v37, v37, v15, s[78:79]
  v_cndmask_b32 v38, v38, v15, s[80:81]
  v_cndmask_b32 v39, v39, v15, s[82:83]
  v_cndmask_b32 v40, v40, v15, s[84:85]
  v_cndmask_b32 v41, v41, v15, s[86:87]
  v_cndmask_b32 v42, v42, v15, s[88:89]
  v_cndmask_b32 v43, v43, v15, s[90:91]
  v_cndmask_b32 v44, v44, v15, s[92:93]
  v_cndmask_b32 v45, v45, v15, s[94:95]
  v_cndmask_b32 v46, v46, v15, s[96:97]
  v_cndmask_b32 v47, v47, v15, s[98:99]
  v_cndmask_b32 v160, v15, v160, s[68:69]
  v_cndmask_b32 v161, v15, v161, s[70:71]
  v_cndmask_b32 v162, v15, v162, s[72:73]
  v_cndmask_b32 v163, v15, v163, s[74:75]
  v_cndmask_b32 v164, v15, v164, s[76:77]
  v_cndmask_b32 v165, v15, v165, s[78:79]
  v_cndmask_b32 v166, v15, v166, s[80:81]
  v_cndmask_b32 v167, v15, v167, s[82:83]
  v_cndmask_b32 v168, v15, v168, s[84:85]
  v_cndmask_b32 v169, v15, v169, s[86:87]
  v_cndmask_b32 v170, v15, v170, s[88:89]
  v_cndmask_b32 v171, v15, v171, s[90:91]
  v_cndmask_b32 v172, v15, v172, s[92:93]
  v_cndmask_b32 v173, v15, v173, s[94:95]
  v_cndmask_b32 v174, v15, v174, s[96:97]
  v_cndmask_b32 v175, v15, v175, s[98:99]
L_a2_mx:
  s_mov_b32 exec_lo, 0x000fffff
  s_mov_b32 exec_hi, 0x000fffff
  ds_read_b128 v[192:195], v10 offset:0
  ds_read_b128 v[196:199], v10 offset:640
  s_mov_b64 exec, -1
  v_max3_f32 v12, v32, v33, v34
  v_max3_f32 v13, v35, v36, v37
  v_max3_f32 v12, v12, v38, v39
  v_max3_f32 v13, v13, v40, v41
  v_max3_f32 v12, v12, v42, v43
  v_max3_f32 v13, v13, v44, v45
  v_max3_f32 v12, v12, v46, v47
  v_max3_f32 v13, v13, v48, v49
  v_max3_f32 v12, v12, v50, v51
  v_max3_f32 v13, v13, v52, v53
  v_max3_f32 v12, v12, v54, v55
  v_max3_f32 v13, v13, v56, v57
  v_max3_f32 v12, v12, v58, v59
  v_max3_f32 v13, v13, v60, v61
  v_max3_f32 v12, v12, v62, v63
  v_max3_f32 v13, v13, v64, v65
  v_max3_f32 v12, v12, v66, v67
  v_max3_f32 v13, v13, v68, v69
  v_max3_f32 v12, v12, v70, v71
  v_max3_f32 v13, v13, v72, v73
  v_max3_f32 v12, v12, v74, v75
  v_max3_f32 v13, v13, v76, v77
  v_max3_f32 v12, v12, v78, v79
  v_max3_f32 v13, v13, v80, v81
  v_max3_f32 v12, v12, v82, v83
  v_max3_f32 v13, v13, v84, v85
  v_max3_f32 v12, v12, v86, v87
  v_max3_f32 v13, v13, v88, v89
  v_max3_f32 v12, v12, v90, v91
  v_max3_f32 v13, v13, v92, v93
  v_max3_f32 v12, v12, v94, v95
  v_max3_f32 v13, v13, v96, v97
  v_max3_f32 v12, v12, v98, v99
  v_max3_f32 v13, v13, v100, v101
  v_max3_f32 v12, v12, v102, v103
  v_max3_f32 v13, v13, v104, v105
  v_max3_f32 v12, v12, v106, v107
  v_max3_f32 v13, v13, v108, v109
  v_max3_f32 v12, v12, v110, v111
  v_max3_f32 v13, v13, v112, v113
  v_max3_f32 v12, v12, v114, v115
  v_max3_f32 v13, v13, v116, v117
  v_max3_f32 v12, v12, v118, v119
  v_max3_f32 v13, v13, v120, v121
  v_max3_f32 v12, v12, v122, v123
  v_max3_f32 v13, v13, v124, v125
  v_max3_f32 v12, v12, v126, v127
  v_max3_f32 v13, v13, v128, v129
  v_max3_f32 v12, v12, v130, v131
  v_max3_f32 v13, v13, v132, v133
  v_max3_f32 v12, v12, v134, v135
  v_max3_f32 v13, v13, v136, v137
  v_max3_f32 v12, v12, v138, v139
  v_max3_f32 v13, v13, v140, v141
  v_max3_f32 v12, v12, v142, v143
  v_max3_f32 v13, v13, v144, v145
  v_max3_f32 v12, v12, v146, v147
  v_max3_f32 v13, v13, v148, v149
  v_max3_f32 v12, v12, v150, v151
  v_max3_f32 v13, v13, v152, v153
  v_max3_f32 v12, v12, v154, v155
  v_max3_f32 v13, v13, v156, v157
  v_max3_f32 v12, v12, v158, v159
  v_max3_f32 v13, v13, v160, v161
  v_max3_f32 v12, v12, v162, v163
  v_max3_f32 v13, v13, v164, v165
  v_max3_f32 v12, v12, v166, v167
  v_max3_f32 v13, v13, v168, v169
  v_max3_f32 v12, v12, v170, v171
  v_max3_f32 v13, v13, v172, v173
  v_max3_f32 v12, v12, v174, v175
  v_max_f32 v12, v12, v13
  v_mov_b32 v13, v12
  s_nop 1
  v_permlane32_swap_b32 v12, v13
  v_max_f32 v12, v12, v13
  v_mul_f32 v12, s53, v12
  v_pk_fma_f32 v[32:33], v[32:33], s[52:53], v[12:13] op_sel_hi:[1,0,0]
  v_pk_fma_f32 v[34:35], v[34:35], s[52:53], v[12:13] op_sel_hi:[1,0,0]
  v_pk_fma_f32 v[36:37], v[36:37], s[52:53], v[12:13] op_sel_hi:[1,0,0]
  v_pk_fma_f32 v[38:39], v[38:39], s[52:53], v[12:13] op_sel_hi:[1,0,0]
  v_pk_fma_f32 v[40:41], v[40:41], s[52:53], v[12:13] op_sel_hi:[1,0,0]
  v_pk_fma_f32 v[42:43], v[42:43], s[52:53], v[12:13] op_sel_hi:[1,0,0]
  v_pk_fma_f32 v[44:45], v[44:45], s[52:53], v[12:13] op_sel_hi:[1,0,0]
  v_pk_fma_f32 v[46:47], v[46:47], s[52:53], v[12:13] op_sel_hi:[1,0,0]
  v_exp_f32 v32, v32
  v_exp_f32 v33, v33
  v_exp_f32 v34, v34
  v_exp_f32 v35, v35
  v_exp_f32 v36, v36
  v_exp_f32 v37, v37
  v_exp_f32 v38, v38
  v_exp_f32 v39, v39
  v_exp_f32 v40, v40
  v_exp_f32 v41, v41
  v_exp_f32 v42, v42
  v_exp_f32 v43, v43
  v_exp_f32 v44, v44
  v_exp_f32 v45, v45
  v_exp_f32 v46, v46
  v_exp_f32 v47, v47
  v_cvt_pk_bf16_f32 v32, v32, v33
  v_cvt_pk_bf16_f32 v33, v34, v35
  v_cvt_pk_bf16_f32 v34, v36, v37
  v_cvt_pk_bf16_f32 v35, v38, v39
  v_cvt_pk_bf16_f32 v36, v40, v41
  v_cvt_pk_bf16_f32 v37, v42, v43
  v_cvt_pk_bf16_f32 v38, v44, v45
  v_cvt_pk_bf16_f32 v39, v46, v47
  s_waitcnt lgkmcnt(0)
  v_mfma_f32_32x32x16_bf16 v[16:31], v[192:195], v[32:35], 0
  v_mfma_f32_32x32x16_bf16 v[16:31], v[196:199], v[36:39], v[16:31]
  s_mov_b32 exec_lo, 0x000fffff
  s_mov_b32 exec_hi, 0x000fffff
  ds_read_b128 v[200:203], v10 offset:1280
  ds_read_b128 v[204:207], v10 offset:1920
  s_mov_b64 exec, -1
  v_pk_fma_f32 v[48:49], v[48:49], s[52:53], v[12:13] op_sel_hi:[1,0,0]
  v_pk_fma_f32 v[50:51], v[50:51], s[52:53], v[12:13] op_sel_hi:[1,0,0]
  v_pk_fma_f32 v[52:53], v[52:53], s[52:53], v[12:13] op_sel_hi:[1,0,0]
  v_pk_fma_f32 v[54:55], v[54:55], s[52:53], v[12:13] op_sel_hi:[1,0,0]
  v_pk_fma_f32 v[56:57], v[56:57], s[52:53], v[12:13] op_sel_hi:[1,0,0]
  v_pk_fma_f32 v[58:59], v[58:59], s[52:53], v[12:13] op_sel_hi:[1,0,0]
  v_pk_fma_f32 v[60:61], v[60:61], s[52:53], v[12:13] op_sel_hi:[1,0,0]
  v_pk_fma_f32 v[62:63], v[62:63], s[52:53], v[12:13] op_sel_hi:[1,0,0]
  v_exp_f32 v48, v48
  v_exp_f32 v49, v49
  v_exp_f32 v50, v50
  v_exp_f32 v51, v51
  v_exp_f32 v52, v52
  v_exp_f32 v53, v53
  v_exp_f32 v54, v54
  v_exp_f32 v55, v55
  v_exp_f32 v56, v56
  v_exp_f32 v57, v57
  v_exp_f32 v58, v58
  v_exp_f32 v59, v59
  v_exp_f32 v60, v60
  v_exp_f32 v61, v61
  v_exp_f32 v62, v62
  v_exp_f32 v63, v63
  v_cvt_pk_bf16_f32 v48, v48, v49
  v_cvt_pk_bf16_f32 v49, v50, v51
  v_cvt_pk_bf16_f32 v50, v52, v53
  v_cvt_pk_bf16_f32 v51, v54, v55
  v_cvt_pk_bf16_f32 v52, v56, v57
  v_cvt_pk_bf16_f32 v53, v58, v59
  v_cvt_pk_bf16_f32 v54, v60, v61
  v_cvt_pk_bf16_f32 v55, v62, v63
  s_waitcnt lgkmcnt(0)
  v_mfma_f32_32x32x16_bf16 v[16:31], v[200:203], v[48:51], v[16:31]
  v_mfma_f32_32x32x16_bf16 v[16:31], v[204:207], v[52:55], v[16:31]
  s_mov_b32 exec_lo, 0x000fffff
  s_mov_b32 exec_hi, 0x000fffff
  ds_read_b128 v[192:195], v10 offset:2560
  ds_read_b128 v[196:199], v10 offset:3200
  s_mov_b64 exec, -1
  v_pk_fma_f32 v[64:65], v[64:65], s[52:53], v[12:13] op_sel_hi:[1,0,0]
  v_pk_fma_f32 v[66:67], v[66:67], s[52:53], v[12:13] op_sel_hi:[1,0,0]
  v_pk_fma_f32 v[68:69], v[68:69], s[52:53], v[12:13] op_sel_hi:[1,0,0]
  v_pk_fma_f32 v[70:71], v[70:71], s[52:53], v[12:13] op_sel_hi:[1,0,0]
  v_pk_fma_f32 v[72:73], v[72:73], s[52:53], v[12:13] op_sel_hi:[1,0,0]
  v_pk_fma_f32 v[74:75], v[74:75], s[52:53], v[12:13] op_sel_hi:[1,0,0]
  v_pk_fma_f32 v[76:77], v[76:77], s[52:53], v[12:13] op_sel_hi:[1,0,0]
  v_pk_fma_f32 v[78:79], v[78:79], s[52:53], v[12:13] op_sel_hi:[1,0,0]
  v_exp_f32 v64, v64
  v_exp_f32 v65, v65
  v_exp_f32 v66, v66
  v_exp_f32 v67, v67
  v_exp_f32 v68, v68
  v_exp_f32 v69, v69
  v_exp_f32 v70, v70
  v_exp_f32 v71, v71
  v_exp_f32 v72, v72
  v_exp_f32 v73, v73
  v_exp_f32 v74, v74
  v_exp_f32 v75, v75
  v_exp_f32 v76, v76
  v_exp_f32 v77, v77
  v_exp_f32 v78, v78
  v_exp_f32 v79, v79
  v_cvt_pk_bf16_f32 v64, v64, v65
  v_cvt_pk_bf16_f32 v65, v66, v67
  v_cvt_pk_bf16_f32 v66, v68, v69
  v_cvt_pk_bf16_f32 v67, v70, v71
  v_cvt_pk_bf16_f32 v68, v72, v73
  v_cvt_pk_bf16_f32 v69, v74, v75
  v_cvt_pk_bf16_f32 v70, v76, v77
  v_cvt_pk_bf16_f32 v71, v78, v79
  s_waitcnt lgkmcnt(0)
  v_mfma_f32_32x32x16_bf16 v[16:31], v[192:195], v[64:67], v[16:31]
  v_mfma_f32_32x32x16_bf16 v[16:31], v[196:199], v[68:71], v[16:31]
  s_mov_b32 exec_lo, 0x000fffff
  s_mov_b32 exec_hi, 0x000fffff
  ds_read_b128 v[200:203], v10 offset:3840
  ds_read_b128 v[204:207], v10 offset:4480
  s_mov_b64 exec, -1
  v_pk_fma_f32 v[80:81], v[80:81], s[52:53], v[12:13] op_sel_hi:[1,0,0]
  v_pk_fma_f32 v[82:83], v[82:83], s[52:53], v[12:13] op_sel_hi:[1,0,0]
  v_pk_fma_f32 v[84:85], v[84:85], s[52:53], v[12:13] op_sel_hi:[1,0,0]
  v_pk_fma_f32 v[86:87], v[86:87], s[52:53], v[12:13] op_sel_hi:[1,0,0]
  v_pk_fma_f32 v[88:89], v[88:89], s[52:53], v[12:13] op_sel_hi:[1,0,0]
  v_pk_fma_f32 v[90:91], v[90:91], s[52:53], v[12:13] op_sel_hi:[1,0,0]
  v_pk_fma_f32 v[92:93], v[92:93], s[52:53], v[12:13] op_sel_hi:[1,0,0]
  v_pk_fma_f32 v[94:95], v[94:95], s[52:53], v[12:13] op_sel_hi:[1,0,0]
  v_exp_f32 v80, v80
  v_exp_f32 v81, v81
  v_exp_f32 v82, v82
  v_exp_f32 v83, v83
  v_exp_f32 v84, v84
  v_exp_f32 v85, v85
  v_exp_f32 v86, v86
  v_exp_f32 v87, v87
  v_exp_f32 v88, v88
  v_exp_f32 v89, v89
  v_exp_f32 v90, v90
  v_exp_f32 v91, v91
  v_exp_f32 v92, v92
  v_exp_f32 v93, v93
  v_exp_f32 v94, v94
  v_exp_f32 v95, v95
  v_cvt_pk_bf16_f32 v80, v80, v81
  v_cvt_pk_bf16_f32 v81, v82, v83
  v_cvt_pk_bf16_f32 v82, v84, v85
  v_cvt_pk_bf16_f32 v83, v86, v87
  v_cvt_pk_bf16_f32 v84, v88, v89
  v_cvt_pk_bf16_f32 v85, v90, v91
  v_cvt_pk_bf16_f32 v86, v92, v93
  v_cvt_pk_bf16_f32 v87, v94, v95
  s_waitcnt lgkmcnt(0)
  v_mfma_f32_32x32x16_bf16 v[16:31], v[200:203], v[80:83], v[16:31]
  v_mfma_f32_32x32x16_bf16 v[16:31], v[204:207], v[84:87], v[16:31]
  s_mov_b32 exec_lo, 0x000fffff
  s_mov_b32 exec_hi, 0x000fffff
  ds_read_b128 v[192:195], v10 offset:5120
  ds_read_b128 v[196:199], v10 offset:5760
  s_mov_b64 exec, -1
  v_pk_fma_f32 v[96:97], v[96:97], s[52:53], v[12:13] op_sel_hi:[1,0,0]
  v_pk_fma_f32 v[98:99], v[98:99], s[52:53], v[12:13] op_sel_hi:[1,0,0]
  v_pk_fma_f32 v[100:101], v[100:101], s[52:53], v[12:13] op_sel_hi:[1,0,0]
  v_pk_fma_f32 v[102:103], v[102:103], s[52:53], v[12:13] op_sel_hi:[1,0,0]
  v_pk_fma_f32 v[104:105], v[104:105], s[52:53], v[12:13] op_sel_hi:[1,0,0]
  v_pk_fma_f32 v[106:107], v[106:107], s[52:53], v[12:13] op_sel_hi:[1,0,0]
  v_pk_fma_f32 v[108:109], v[108:109], s[52:53], v[12:13] op_sel_hi:[1,0,0]
  v_pk_fma_f32 v[110:111], v[110:111], s[52:53], v[12:13] op_sel_hi:[1,0,0]
  v_exp_f32 v96, v96
  v_exp_f32 v97, v97
  v_exp_f32 v98, v98
  v_exp_f32 v99, v99
  v_exp_f32 v100, v100
  v_exp_f32 v101, v101
  v_exp_f32 v102, v102
  v_exp_f32 v103, v103
  v_exp_f32 v104, v104
  v_exp_f32 v105, v105
  v_exp_f32 v106, v106
  v_exp_f32 v107, v107
  v_exp_f32 v108, v108
  v_exp_f32 v109, v109
  v_exp_f32 v110, v110
  v_exp_f32 v111, v111
  v_cvt_pk_bf16_f32 v96, v96, v97
  v_cvt_pk_bf16_f32 v97, v98, v99
  v_cvt_pk_bf16_f32 v98, v100, v101
  v_cvt_pk_bf16_f32 v99, v102, v103
  v_cvt_pk_bf16_f32 v100, v104, v105
  v_cvt_pk_bf16_f32 v101, v106, v107
  v_cvt_pk_bf16_f32 v102, v108, v109
  v_cvt_pk_bf16_f32 v103, v110, v111
  s_waitcnt lgkmcnt(0)
  v_mfma_f32_32x32x16_bf16 v[16:31], v[192:195], v[96:99], v[16:31]
  v_mfma_f32_32x32x16_bf16 v[16:31], v[196:199], v[100:103], v[16:31]
  s_mov_b32 exec_lo, 0x000fffff
  s_mov_b32 exec_hi, 0x000fffff
  ds_read_b128 v[200:203], v10 offset:6400
  ds_read_b128 v[204:207], v10 offset:7040
  s_mov_b64 exec, -1
  v_pk_fma_f32 v[112:113], v[112:113], s[52:53], v[12:13] op_sel_hi:[1,0,0]
  v_pk_fma_f32 v[114:115], v[114:115], s[52:53], v[12:13] op_sel_hi:[1,0,0]
  v_pk_fma_f32 v[116:117], v[116:117], s[52:53], v[12:13] op_sel_hi:[1,0,0]
  v_pk_fma_f32 v[118:119], v[118:119], s[52:53], v[12:13] op_sel_hi:[1,0,0]
  v_pk_fma_f32 v[120:121], v[120:121], s[52:53], v[12:13] op_sel_hi:[1,0,0]
  v_pk_fma_f32 v[122:123], v[122:123], s[52:53], v[12:13] op_sel_hi:[1,0,0]
  v_pk_fma_f32 v[124:125], v[124:125], s[52:53], v[12:13] op_sel_hi:[1,0,0]
  v_pk_fma_f32 v[126:127], v[126:127], s[52:53], v[12:13] op_sel_hi:[1,0,0]
  v_exp_f32 v112, v112
  v_exp_f32 v113, v113
  v_exp_f32 v114, v114
  v_exp_f32 v115, v115
  v_exp_f32 v116, v116
  v_exp_f32 v117, v117
  v_exp_f32 v118, v118
  v_exp_f32 v119, v119
  v_exp_f32 v120, v120
  v_exp_f32 v121, v121
  v_exp_f32 v122, v122
  v_exp_f32 v123, v123
  v_exp_f32 v124, v124
  v_exp_f32 v125, v125
  v_exp_f32 v126, v126
  v_exp_f32 v127, v127
  v_cvt_pk_bf16_f32 v112, v112, v113
  v_cvt_pk_bf16_f32 v113, v114, v115
  v_cvt_pk_bf16_f32 v114, v116, v117
  v_cvt_pk_bf16_f32 v115, v118, v119
  v_cvt_pk_bf16_f32 v116, v120, v121
  v_cvt_pk_bf16_f32 v117, v122, v123
  v_cvt_pk_bf16_f32 v118, v124, v125
  v_cvt_pk_bf16_f32 v119, v126, v127
  s_waitcnt lgkmcnt(0)
  v_mfma_f32_32x32x16_bf16 v[16:31], v[200:203], v[112:115], v[16:31]
  v_mfma_f32_32x32x16_bf16 v[16:31], v[204:207], v[116:119], v[16:31]
  s_mov_b32 exec_lo, 0x000fffff
  s_mov_b32 exec_hi, 0x000fffff
  ds_read_b128 v[192:195], v10 offset:7680
  ds_read_b128 v[196:199], v10 offset:8320
  s_mov_b64 exec, -1
  v_pk_fma_f32 v[128:129], v[128:129], s[52:53], v[12:13] op_sel_hi:[1,0,0]
  v_pk_fma_f32 v[130:131], v[130:131], s[52:53], v[12:13] op_sel_hi:[1,0,0]
  v_pk_fma_f32 v[132:133], v[132:133], s[52:53], v[12:13] op_sel_hi:[1,0,0]
  v_pk_fma_f32 v[134:135], v[134:135], s[52:53], v[12:13] op_sel_hi:[1,0,0]
  v_pk_fma_f32 v[136:137], v[136:137], s[52:53], v[12:13] op_sel_hi:[1,0,0]
  v_pk_fma_f32 v[138:139], v[138:139], s[52:53], v[12:13] op_sel_hi:[1,0,0]
  v_pk_fma_f32 v[140:141], v[140:141], s[52:53], v[12:13] op_sel_hi:[1,0,0]
  v_pk_fma_f32 v[142:143], v[142:143], s[52:53], v[12:13] op_sel_hi:[1,0,0]
  v_exp_f32 v128, v128
  v_exp_f32 v129, v129
  v_exp_f32 v130, v130
  v_exp_f32 v131, v131
  v_exp_f32 v132, v132
  v_exp_f32 v133, v133
  v_exp_f32 v134, v134
  v_exp_f32 v135, v135
  v_exp_f32 v136, v136
  v_exp_f32 v137, v137
  v_exp_f32 v138, v138
  v_exp_f32 v139, v139
  v_exp_f32 v140, v140
  v_exp_f32 v141, v141
  v_exp_f32 v142, v142
  v_exp_f32 v143, v143
  v_cvt_pk_bf16_f32 v128, v128, v129
  v_cvt_pk_bf16_f32 v129, v130, v131
  v_cvt_pk_bf16_f32 v130, v132, v133
  v_cvt_pk_bf16_f32 v131, v134, v135
  v_cvt_pk_bf16_f32 v132, v136, v137
  v_cvt_pk_bf16_f32 v133, v138, v139
  v_cvt_pk_bf16_f32 v134, v140, v141
  v_cvt_pk_bf16_f32 v135, v142, v143
  s_waitcnt lgkmcnt(0)
  v_mfma_f32_32x32x16_bf16 v[16:31], v[192:195], v[128:131], v[16:31]
  v_mfma_f32_32x32x16_bf16 v[16:31], v[196:199], v[132:135], v[16:31]
  s_mov_b32 exec_lo, 0x000fffff
  s_mov_b32 exec_hi, 0x000fffff
  ds_read_b128 v[200:203], v10 offset:8960
  ds_read_b128 v[204:207], v10 offset:9600
  s_mov_b64 exec, -1
  v_pk_fma_f32 v[144:145], v[144:145], s[52:53], v[12:13] op_sel_hi:[1,0,0]
  v_pk_fma_f32 v[146:147], v[146:147], s[52:53], v[12:13] op_sel_hi:[1,0,0]
  v_pk_fma_f32 v[148:149], v[148:149], s[52:53], v[12:13] op_sel_hi:[1,0,0]
  v_pk_fma_f32 v[150:151], v[150:151], s[52:53], v[12:13] op_sel_hi:[1,0,0]
  v_pk_fma_f32 v[152:153], v[152:153], s[52:53], v[12:13] op_sel_hi:[1,0,0]
  v_pk_fma_f32 v[154:155], v[154:155], s[52:53], v[12:13] op_sel_hi:[1,0,0]
  v_pk_fma_f32 v[156:157], v[156:157], s[52:53], v[12:13] op_sel_hi:[1,0,0]
  v_pk_fma_f32 v[158:159], v[158:159], s[52:53], v[12:13] op_sel_hi:[1,0,0]
  v_exp_f32 v144, v144
  v_exp_f32 v145, v145
  v_exp_f32 v146, v146
  v_exp_f32 v147, v147
  v_exp_f32 v148, v148
  v_exp_f32 v149, v149
  v_exp_f32 v150, v150
  v_exp_f32 v151, v151
  v_exp_f32 v152, v152
  v_exp_f32 v153, v153
  v_exp_f32 v154, v154
  v_exp_f32 v155, v155
  v_exp_f32 v156, v156
  v_exp_f32 v157, v157
  v_exp_f32 v158, v158
  v_exp_f32 v159, v159
  v_cvt_pk_bf16_f32 v144, v144, v145
  v_cvt_pk_bf16_f32 v145, v146, v147
  v_cvt_pk_bf16_f32 v146, v148, v149
  v_cvt_pk_bf16_f32 v147, v150, v151
  v_cvt_pk_bf16_f32 v148, v152, v153
  v_cvt_pk_bf16_f32 v149, v154, v155
  v_cvt_pk_bf16_f32 v150, v156, v157
  v_cvt_pk_bf16_f32 v151, v158, v159
  s_waitcnt lgkmcnt(0)
  v_mfma_f32_32x32x16_bf16 v[16:31], v[200:203], v[144:147], v[16:31]
  v_mfma_f32_32x32x16_bf16 v[16:31], v[204:207], v[148:151], v[16:31]
  s_mov_b32 exec_lo, 0x000fffff
  s_mov_b32 exec_hi, 0x000fffff
  ds_read_b128 v[192:195], v10 offset:10240
  ds_read_b128 v[196:199], v10 offset:10880
  s_mov_b64 exec, -1
  v_pk_fma_f32 v[160:161], v[160:161], s[52:53], v[12:13] op_sel_hi:[1,0,0]
  v_pk_fma_f32 v[162:163], v[162:163], s[52:53], v[12:13] op_sel_hi:[1,0,0]
  v_pk_fma_f32 v[164:165], v[164:165], s[52:53], v[12:13] op_sel_hi:[1,0,0]
  v_pk_fma_f32 v[166:167], v[166:167], s[52:53], v[12:13] op_sel_hi:[1,0,0]
  v_pk_fma_f32 v[168:169], v[168:169], s[52:53], v[12:13] op_sel_hi:[1,0,0]
  v_pk_fma_f32 v[170:171], v[170:171], s[52:53], v[12:13] op_sel_hi:[1,0,0]
  v_pk_fma_f32 v[172:173], v[172:173], s[52:53], v[12:13] op_sel_hi:[1,0,0]
  v_pk_fma_f32 v[174:175], v[174:175], s[52:53], v[12:13] op_sel_hi:[1,0,0]
  v_exp_f32 v160, v160
  v_exp_f32 v161, v161
  v_exp_f32 v162, v162
  v_exp_f32 v163, v163
  v_exp_f32 v164, v164
  v_exp_f32 v165, v165
  v_exp_f32 v166, v166
  v_exp_f32 v167, v167
  v_exp_f32 v168, v168
  v_exp_f32 v169, v169
  v_exp_f32 v170, v170
  v_exp_f32 v171, v171
  v_exp_f32 v172, v172
  v_exp_f32 v173, v173
  v_exp_f32 v174, v174
  v_exp_f32 v175, v175
  v_cvt_pk_bf16_f32 v160, v160, v161
  v_cvt_pk_bf16_f32 v161, v162, v163
  v_cvt_pk_bf16_f32 v162, v164, v165
  v_cvt_pk_bf16_f32 v163, v166, v167
  v_cvt_pk_bf16_f32 v164, v168, v169
  v_cvt_pk_bf16_f32 v165, v170, v171
  v_cvt_pk_bf16_f32 v166, v172, v173
  v_cvt_pk_bf16_f32 v167, v174, v175
  s_waitcnt lgkmcnt(0)
  v_mfma_f32_32x32x16_bf16 v[16:31], v[192:195], v[160:163], v[16:31]
  v_mfma_f32_32x32x16_bf16 v[16:31], v[196:199], v[164:167], v[16:31]
  s_nop 11
  v_mov_b32 v12, v24
  v_mov_b32 v13, v24
  s_nop 1
  v_permlane32_swap_b32 v12, v13
  v_rcp_f32 v13, v13
  s_nop 0
  v_mul_f32 v16, v16, v13
  v_mul_f32 v17, v17, v13
  v_mul_f32 v18, v18, v13
  v_mul_f32 v19, v19, v13
  v_mul_f32 v20, v20, v13
  v_mul_f32 v21, v21, v13
  v_mul_f32 v22, v22, v13
  v_mul_f32 v23, v23, v13
  v_mul_f32 v24, v24, v13
  v_mul_f32 v25, v25, v13
  v_mul_f32 v26, v26, v13
  v_mul_f32 v27, v27, v13
  v_cvt_pk_bf16_f32 v16, v16, v17
  v_cvt_pk_bf16_f32 v17, v18, v19
  v_cvt_pk_bf16_f32 v18, v20, v21
  v_cvt_pk_bf16_f32 v19, v22, v23
  v_cvt_pk_bf16_f32 v20, v24, v25
  v_cvt_pk_bf16_f32 v21, v26, v27
  s_mul_i32 s51, s48, 40960
  s_add_u32 s51, s51, 0x9c00000
  buffer_store_dwordx2 v[16:17], v6, s[8:11], s51 offen sc1
  buffer_store_dwordx2 v[18:19], v6, s[8:11], s51 offen offset:16 sc1
  s_mov_b32 exec_hi, 0
  buffer_store_dwordx2 v[20:21], v6, s[8:11], s51 offen offset:32 sc1
  s_mov_b64 exec, -1
  s_add_u32 s48, s48, 8
  s_cmp_lt_u32 s48, 64
  s_cbranch_scc1 L_a2_top
  s_branch L_a2_end
L_a2_head:
  s_cmp_lt_u32 0, s48
  s_cbranch_scc1 L_a2e_25
  s_cmp_eq_u32 0, s48
  s_cbranch_scc1 L_a2d_24
  v_mov_b32 v32, v15
  v_mov_b32 v33, v15
  v_mov_b32 v34, v15
  v_mov_b32 v35, v15
  v_mov_b32 v36, v15
  v_mov_b32 v37, v15
  v_mov_b32 v38, v15
  v_mov_b32 v39, v15
  v_mov_b32 v40, v15
  v_mov_b32 v41, v15
  v_mov_b32 v42, v15
  v_mov_b32 v43, v15
  v_mov_b32 v44, v15
  v_mov_b32 v45, v15
  v_mov_b32 v46, v15
  v_mov_b32 v47, v15
  s_branch L_a2e_25
L_a2d_24:
  v_cndmask_b32 v32, v15, v32, s[68:69]
  v_cndmask_b32 v33, v15, v33, s[70:71]
  v_cndmask_b32 v34, v15, v34, s[72:73]
  v_cndmask_b32 v35, v15, v35, s[74:75]
  v_cndmask_b32 v36, v15, v36, s[76:77]
  v_cndmask_b32 v37, v15, v37, s[78:79]
  v_cndmask_b32 v38, v15, v38, s[80:81]
  v_cndmask_b32 v39, v15, v39, s[82:83]
  v_cndmask_b32 v40, v15, v40, s[84:85]
  v_cndmask_b32 v41, v15, v41, s[86:87]
  v_cndmask_b32 v42, v15, v42, s[88:89]
  v_cndmask_b32 v43, v15, v43, s[90:91]
  v_cndmask_b32 v44, v15, v44, s[92:93]
  v_cndmask_b32 v45, v15, v45, s[94:95]
  v_cndmask_b32 v46, v15, v46, s[96:97]
  v_cndmask_b32 v47, v15, v47, s[98:99]
L_a2e_25:
  s_cmp_lt_u32 1, s48
  s_cbranch_scc1 L_a2e_27
  s_cmp_eq_u32 1, s48
  s_cbranch_scc1 L_a2d_26
  v_mov_b32 v48, v15
  v_mov_b32 v49, v15
  v_mov_b32 v50, v15
  v_mov_b32 v51, v15
  v_mov_b32 v52, v15
  v_mov_b32 v53, v15
  v_mov_b32 v54, v15
  v_mov_b32 v55, v15
  v_mov_b32 v56, v15
  v_mov_b32 v57, v15
  v_mov_b32 v58, v15
  v_mov_b32 v59, v15
  v_mov_b32 v60, v15
  v_mov_b32 v61, v15
  v_mov_b32 v62, v15
  v_mov_b32 v63, v15
  s_branch L_a2e_27
L_a2d_26:
  v_cndmask_b32 v48, v15, v48, s[68:69]
  v_cndmask_b32 v49, v15, v49, s[70:71]
  v_cndmask_b32 v50, v15, v50, s[72:73]
  v_cndmask_b32 v51, v15, v51, s[74:75]
  v_cndmask_b32 v52, v15, v52, s[76:77]
  v_cndmask_b32 v53, v15, v53, s[78:79]
  v_cndmask_b32 v54, v15, v54, s[80:81]
  v_cndmask_b32 v55, v15, v55, s[82:83]
  v_cndmask_b32 v56, v15, v56, s[84:85]
  v_cndmask_b32 v57, v15, v57, s[86:87]
  v_cndmask_b32 v58, v15, v58, s[88:89]
  v_cndmask_b32 v59, v15, v59, s[90:91]
  v_cndmask_b32 v60, v15, v60, s[92:93]
  v_cndmask_b32 v61, v15, v61, s[94:95]
  v_cndmask_b32 v62, v15, v62, s[96:97]
  v_cndmask_b32 v63, v15, v63, s[98:99]
L_a2e_27:
  s_cmp_lt_u32 2, s48
  s_cbranch_scc1 L_a2e_29
  s_cmp_eq_u32 2, s48
  s_cbranch_scc1 L_a2d_28
  v_mov_b32 v64, v15
  v_mov_b32 v65, v15
  v_mov_b32 v66, v15
  v_mov_b32 v67, v15
  v_mov_b32 v68, v15
  v_mov_b32 v69, v15
  v_mov_b32 v70, v15
  v_mov_b32 v71, v15
  v_mov_b32 v72, v15
  v_mov_b32 v73, v15
  v_mov_b32 v74, v15
  v_mov_b32 v75, v15
  v_mov_b32 v76, v15
  v_mov_b32 v77, v15
  v_mov_b32 v78, v15
  v_mov_b32 v79, v15
  s_branch L_a2e_29
L_a2d_28:
  v_cndmask_b32 v64, v15, v64, s[68:69]
  v_cndmask_b32 v65, v15, v65, s[70:71]
  v_cndmask_b32 v66, v15, v66, s[72:73]
  v_cndmask_b32 v67, v15, v67, s[74:75]
  v_cndmask_b32 v68, v15, v68, s[76:77]
  v_cndmask_b32 v69, v15, v69, s[78:79]
  v_cndmask_b32 v70, v15, v70, s[80:81]
  v_cndmask_b32 v71, v15, v71, s[82:83]
  v_cndmask_b32 v72, v15, v72, s[84:85]
  v_cndmask_b32 v73, v15, v73, s[86:87]
  v_cndmask_b32 v74, v15, v74, s[88:89]
  v_cndmask_b32 v75, v15, v75, s[90:91]
  v_cndmask_b32 v76, v15, v76, s[92:93]
  v_cndmask_b32 v77, v15, v77, s[94:95]
  v_cndmask_b32 v78, v15, v78, s[96:97]
  v_cndmask_b32 v79, v15, v79, s[98:99]
L_a2e_29:
  s_cmp_lt_u32 3, s48
  s_cbranch_scc1 L_a2e_31
  s_cmp_eq_u32 3, s48
  s_cbranch_scc1 L_a2d_30
  v_mov_b32 v80, v15
  v_mov_b32 v81, v15
  v_mov_b32 v82, v15
  v_mov_b32 v83, v15
  v_mov_b32 v84, v15
  v_mov_b32 v85, v15
  v_mov_b32 v86, v15
  v_mov_b32 v87, v15
  v_mov_b32 v88, v15
  v_mov_b32 v89, v15
  v_mov_b32 v90, v15
  v_mov_b32 v91, v15
  v_mov_b32 v92, v15
  v_mov_b32 v93, v15
  v_mov_b32 v94, v15
  v_mov_b32 v95, v15
  s_branch L_a2e_31
L_a2d_30:
  v_cndmask_b32 v80, v15, v80, s[68:69]
  v_cndmask_b32 v81, v15, v81, s[70:71]
  v_cndmask_b32 v82, v15, v82, s[72:73]
  v_cndmask_b32 v83, v15, v83, s[74:75]
  v_cndmask_b32 v84, v15, v84, s[76:77]
  v_cndmask_b32 v85, v15, v85, s[78:79]
  v_cndmask_b32 v86, v15, v86, s[80:81]
  v_cndmask_b32 v87, v15, v87, s[82:83]
  v_cndmask_b32 v88, v15, v88, s[84:85]
  v_cndmask_b32 v89, v15, v89, s[86:87]
  v_cndmask_b32 v90, v15, v90, s[88:89]
  v_cndmask_b32 v91, v15, v91, s[90:91]
  v_cndmask_b32 v92, v15, v92, s[92:93]
  v_cndmask_b32 v93, v15, v93, s[94:95]
  v_cndmask_b32 v94, v15, v94, s[96:97]
  v_cndmask_b32 v95, v15, v95, s[98:99]
L_a2e_31:
  s_cmp_lt_u32 4, s48
  s_cbranch_scc1 L_a2e_33
  s_cmp_eq_u32 4, s48
  s_cbranch_scc1 L_a2d_32
  v_mov_b32 v96, v15
  v_mov_b32 v97, v15
  v_mov_b32 v98, v15
  v_mov_b32 v99, v15
  v_mov_b32 v100, v15
  v_mov_b32 v101, v15
  v_mov_b32 v102, v15
  v_mov_b32 v103, v15
  v_mov_b32 v104, v15
  v_mov_b32 v105, v15
  v_mov_b32 v106, v15
  v_mov_b32 v107, v15
  v_mov_b32 v108, v15
  v_mov_b32 v109, v15
  v_mov_b32 v110, v15
  v_mov_b32 v111, v15
  s_branch L_a2e_33
L_a2d_32:
  v_cndmask_b32 v96, v15, v96, s[68:69]
  v_cndmask_b32 v97, v15, v97, s[70:71]
  v_cndmask_b32 v98, v15, v98, s[72:73]
  v_cndmask_b32 v99, v15, v99, s[74:75]
  v_cndmask_b32 v100, v15, v100, s[76:77]
  v_cndmask_b32 v101, v15, v101, s[78:79]
  v_cndmask_b32 v102, v15, v102, s[80:81]
  v_cndmask_b32 v103, v15, v103, s[82:83]
  v_cndmask_b32 v104, v15, v104, s[84:85]
  v_cndmask_b32 v105, v15, v105, s[86:87]
  v_cndmask_b32 v106, v15, v106, s[88:89]
  v_cndmask_b32 v107, v15, v107, s[90:91]
  v_cndmask_b32 v108, v15, v108, s[92:93]
  v_cndmask_b32 v109, v15, v109, s[94:95]
  v_cndmask_b32 v110, v15, v110, s[96:97]
  v_cndmask_b32 v111, v15, v111, s[98:99]
L_a2e_33:
  s_cmp_lt_u32 5, s48
  s_cbranch_scc1 L_a2e_35
  s_cmp_eq_u32 5, s48
  s_cbranch_scc1 L_a2d_34
  v_mov_b32 v112, v15
  v_mov_b32 v113, v15
  v_mov_b32 v114, v15
  v_mov_b32 v115, v15
  v_mov_b32 v116, v15
  v_mov_b32 v117, v15
  v_mov_b32 v118, v15
  v_mov_b32 v119, v15
  v_mov_b32 v120, v15
  v_mov_b32 v121, v15
  v_mov_b32 v122, v15
  v_mov_b32 v123, v15
  v_mov_b32 v124, v15
  v_mov_b32 v125, v15
  v_mov_b32 v126, v15
  v_mov_b32 v127, v15
  s_branch L_a2e_35
L_a2d_34:
  v_cndmask_b32 v112, v15, v112, s[68:69]
  v_cndmask_b32 v113, v15, v113, s[70:71]
  v_cndmask_b32 v114, v15, v114, s[72:73]
  v_cndmask_b32 v115, v15, v115, s[74:75]
  v_cndmask_b32 v116, v15, v116, s[76:77]
  v_cndmask_b32 v117, v15, v117, s[78:79]
  v_cndmask_b32 v118, v15, v118, s[80:81]
  v_cndmask_b32 v119, v15, v119, s[82:83]
  v_cndmask_b32 v120, v15, v120, s[84:85]
  v_cndmask_b32 v121, v15, v121, s[86:87]
  v_cndmask_b32 v122, v15, v122, s[88:89]
  v_cndmask_b32 v123, v15, v123, s[90:91]
  v_cndmask_b32 v124, v15, v124, s[92:93]
  v_cndmask_b32 v125, v15, v125, s[94:95]
  v_cndmask_b32 v126, v15, v126, s[96:97]
  v_cndmask_b32 v127, v15, v127, s[98:99]
L_a2e_35:
  s_cmp_lt_u32 6, s48
  s_cbranch_scc1 L_a2e_37
  s_cmp_eq_u32 6, s48
  s_cbranch_scc1 L_a2d_36
  v_mov_b32 v128, v15
  v_mov_b32 v129, v15
  v_mov_b32 v130, v15
  v_mov_b32 v131, v15
  v_mov_b32 v132, v15
  v_mov_b32 v133, v15
  v_mov_b32 v134, v15
  v_mov_b32 v135, v15
  v_mov_b32 v136, v15
  v_mov_b32 v137, v15
  v_mov_b32 v138, v15
  v_mov_b32 v139, v15
  v_mov_b32 v140, v15
  v_mov_b32 v141, v15
  v_mov_b32 v142, v15
  v_mov_b32 v143, v15
  s_branch L_a2e_37
L_a2d_36:
  v_cndmask_b32 v128, v15, v128, s[68:69]
  v_cndmask_b32 v129, v15, v129, s[70:71]
  v_cndmask_b32 v130, v15, v130, s[72:73]
  v_cndmask_b32 v131, v15, v131, s[74:75]
  v_cndmask_b32 v132, v15, v132, s[76:77]
  v_cndmask_b32 v133, v15, v133, s[78:79]
  v_cndmask_b32 v134, v15, v134, s[80:81]
  v_cndmask_b32 v135, v15, v135, s[82:83]
  v_cndmask_b32 v136, v15, v136, s[84:85]
  v_cndmask_b32 v137, v15, v137, s[86:87]
  v_cndmask_b32 v138, v15, v138, s[88:89]
  v_cndmask_b32 v139, v15, v139, s[90:91]
  v_cndmask_b32 v140, v15, v140, s[92:93]
  v_cndmask_b32 v141, v15, v141, s[94:95]
  v_cndmask_b32 v142, v15, v142, s[96:97]
  v_cndmask_b32 v143, v15, v143, s[98:99]
L_a2e_37:
  s_cmp_lt_u32 7, s48
  s_cbranch_scc1 L_a2e_39
  s_cmp_eq_u32 7, s48
  s_cbranch_scc1 L_a2d_38
  v_mov_b32 v144, v15
  v_mov_b32 v145, v15
  v_mov_b32 v146, v15
  v_mov_b32 v147, v15
  v_mov_b32 v148, v15
  v_mov_b32 v149, v15
  v_mov_b32 v150, v15
  v_mov_b32 v151, v15
  v_mov_b32 v152, v15
  v_mov_b32 v153, v15
  v_mov_b32 v154, v15
  v_mov_b32 v155, v15
  v_mov_b32 v156, v15
  v_mov_b32 v157, v15
  v_mov_b32 v158, v15
  v_mov_b32 v159, v15
  s_branch L_a2e_39
L_a2d_38:
  v_cndmask_b32 v144, v15, v144, s[68:69]
  v_cndmask_b32 v145, v15, v145, s[70:71]
  v_cndmask_b32 v146, v15, v146, s[72:73]
  v_cndmask_b32 v147, v15, v147, s[74:75]
  v_cndmask_b32 v148, v15, v148, s[76:77]
  v_cndmask_b32 v149, v15, v149, s[78:79]
  v_cndmask_b32 v150, v15, v150, s[80:81]
  v_cndmask_b32 v151, v15, v151, s[82:83]
  v_cndmask_b32 v152, v15, v152, s[84:85]
  v_cndmask_b32 v153, v15, v153, s[86:87]
  v_cndmask_b32 v154, v15, v154, s[88:89]
  v_cndmask_b32 v155, v15, v155, s[90:91]
  v_cndmask_b32 v156, v15, v156, s[92:93]
  v_cndmask_b32 v157, v15, v157, s[94:95]
  v_cndmask_b32 v158, v15, v158, s[96:97]
  v_cndmask_b32 v159, v15, v159, s[98:99]
L_a2e_39:
  s_cmp_lt_u32 8, s48
  s_cbranch_scc1 L_a2e_41
  s_cmp_eq_u32 8, s48
  s_cbranch_scc1 L_a2d_40
  v_mov_b32 v160, v15
  v_mov_b32 v161, v15
  v_mov_b32 v162, v15
  v_mov_b32 v163, v15
  v_mov_b32 v164, v15
  v_mov_b32 v165, v15
  v_mov_b32 v166, v15
  v_mov_b32 v167, v15
  v_mov_b32 v168, v15
  v_mov_b32 v169, v15
  v_mov_b32 v170, v15
  v_mov_b32 v171, v15
  v_mov_b32 v172, v15
  v_mov_b32 v173, v15
  v_mov_b32 v174, v15
  v_mov_b32 v175, v15
  s_branch L_a2e_41
L_a2d_40:
  v_cndmask_b32 v160, v15, v160, s[68:69]
  v_cndmask_b32 v161, v15, v161, s[70:71]
  v_cndmask_b32 v162, v15, v162, s[72:73]
  v_cndmask_b32 v163, v15, v163, s[74:75]
  v_cndmask_b32 v164, v15, v164, s[76:77]
  v_cndmask_b32 v165, v15, v165, s[78:79]
  v_cndmask_b32 v166, v15, v166, s[80:81]
  v_cndmask_b32 v167, v15, v167, s[82:83]
  v_cndmask_b32 v168, v15, v168, s[84:85]
  v_cndmask_b32 v169, v15, v169, s[86:87]
  v_cndmask_b32 v170, v15, v170, s[88:89]
  v_cndmask_b32 v171, v15, v171, s[90:91]
  v_cndmask_b32 v172, v15, v172, s[92:93]
  v_cndmask_b32 v173, v15, v173, s[94:95]
  v_cndmask_b32 v174, v15, v174, s[96:97]
  v_cndmask_b32 v175, v15, v175, s[98:99]
L_a2e_41:
  s_branch L_a2_mx
L_a2_end:
  s_waitcnt vmcnt(0)
  s_barrier
  s_cmp_eq_u32 s3, 0
  s_cbranch_scc0 L_ca_42
  v_mov_b32 v12, 0x281100
  v_mov_b32 v13, 1
  s_mov_b64 exec, 1
  buffer_atomic_add v13, v12, s[8:11], 0 offen sc1
  s_mov_b64 exec, -1
L_ca_42:
  s_branch L_b_T
L_b_A4:
  s_waitcnt vmcnt(0)
  s_barrier
L_b_T:
  s_mov_b32 s6, 65536
  v_mov_b32 v15, 8
L_sd_43:
  buffer_load_dwordx3 v[12:14], v15, s[12:15], 0 offen sc1
  s_waitcnt vmcnt(0)
  v_readfirstlane_b32 s67, v14
  s_cmp_ge_u32 s67, 2
  s_cbranch_scc1 L_se_44
  s_sleep 8
  s_sub_u32 s6, s6, 1
  s_cmp_lg_u32 s6, 0
  s_cbranch_scc1 L_sd_43
  s_endpgm
L_se_44:
  v_readfirstlane_b32 s67, v12
  s_cmp_gt_i32 s67, 0
  s_cselect_b32 s67, 0x2000, 0
  s_lshl_b32 s6, s46, 3
  s_add_u32 s6, s6, s3
  s_cmp_lt_u32 s6, 1000
  s_cbranch_scc0 L_END
  s_mul_i32 s49, s6, 1639
  s_lshr_b32 s49, s49, 16
  s_mul_i32 s7, s49, 40
  s_sub_u32 s48, s6, s7
  s_mov_b32 s52, 0x3f80
  s_mov_b32 s53, 0x3f800000
  s_lshr_b32 s6, s48, 2
  s_lshl_b32 s6, s6, 3
  v_and_b32 v12, 7, v1
  v_add_u32 v12, s6, v12
  v_lshrrev_b32 v13, 6, v12
  v_and_b32 v12, 63, v12
  v_lshlrev_b32 v12, 7, v12
  v_lshl_add_u32 v3, v13, 14, v12
  s_xor_b32 s67, s67, 0x2000
  s_add_u32 s67, s67, 0x290000
  v_lshlrev_b32 v4, 3, v1
  v_and_b32 v12, 15, v1
  v_mul_u32_u24 v12, 2560, v12
  v_lshrrev_b32 v13, 4, v1
  v_lshl_add_u32 v12, v13, 3, v12
  s_lshl_b32 s6, s48, 5
  s_add_u32 s6, s6, 1280
  v_add_u32 v2, s6, v12
L_t_top:
  s_mov_b32 s66, 524288
L_t_poll:
  buffer_load_dword v12, v3, s[8:11], s67 offen sc1
  s_waitcnt vmcnt(0)
  v_min_u32 v12, v12, v12 row_ror:4 row_mask:0xf bank_mask:0xf
  s_nop 1
  v_min_u32 v12, v12, v12 row_ror:2 row_mask:0xf bank_mask:0xf
  s_nop 1
  v_min_u32 v12, v12, v12 row_ror:1 row_mask:0xf bank_mask:0xf
  s_nop 0
  v_readfirstlane_b32 s6, v12
  s_sub_i32 s6, s49, s6
  s_cmp_lt_i32 s6, 0
  s_cbranch_scc1 L_t_go
  s_cmp_lt_i32 s6, 2
  s_cbranch_scc1 L_t_near
  s_sleep 40
L_t_near:
  s_sleep 2
  s_sub_u32 s66, s66, 1
  s_cmp_lg_u32 s66, 0
  s_cbranch_scc1 L_t_poll
  s_endpgm
L_t_go:
  s_mul_i32 s50, s49, 40
  s_add_u32 s50, s50, s48
  s_lshl_b32 s50, s50, 13
  s_add_u32 s50, s50, 0x5400000
  s_add_u32 s51, s50, 4096
  buffer_load_dwordx2 v[16:17], v4, s[8:11], s50 offen offset:0 sc1
  buffer_load_dwordx2 v[18:19], v4, s[8:11], s50 offen offset:512 sc1
  buffer_load_dwordx2 v[20:21], v4, s[8:11], s50 offen offset:1024 sc1
  buffer_load_dwordx2 v[22:23], v4, s[8:11], s50 offen offset:1536 sc1
  buffer_load_dwordx2 v[24:25], v4, s[8:11], s50 offen offset:2048 sc1
  buffer_load_dwordx2 v[26:27], v4, s[8:11], s50 offen offset:2560 sc1
  buffer_load_dwordx2 v[28:29], v4, s[8:11], s50 offen offset:3072 sc1
  buffer_load_dwordx2 v[30:31], v4, s[8:11], s50 offen offset:3584 sc1
  buffer_load_dwordx2 v[32:33], v4, s[8:11], s51 offen offset:0 sc1
  buffer_load_dwordx2 v[34:35], v4, s[8:11], s51 offen offset:512 sc1
  buffer_load_dwordx2 v[36:37], v4, s[8:11], s51 offen offset:1024 sc1
  buffer_load_dwordx2 v[38:39], v4, s[8:11], s51 offen offset:1536 sc1
  buffer_load_dwordx2 v[40:41], v4, s[8:11], s51 offen offset:2048 sc1
  buffer_load_dwordx2 v[42:43], v4, s[8:11], s51 offen offset:2560 sc1
  buffer_load_dwordx2 v[44:45], v4, s[8:11], s51 offen offset:3072 sc1
  buffer_load_dwordx2 v[46:47], v4, s[8:11], s51 offen offset:3584 sc1
  s_waitcnt vmcnt(15)
  v_dot2_f32_bf16 v48, v16, s52, 0
  v_dot2_f32_bf16 v49, v16, s53, 0
  v_dot2_f32_bf16 v50, v17, s52, 0
  v_dot2_f32_bf16 v51, v17, s53, 0
  s_waitcnt vmcnt(14)
  v_dot2_f32_bf16 v52, v18, s52, 0
  v_dot2_f32_bf16 v53, v18, s53, 0
  v_dot2_f32_bf16 v54, v19, s52, 0
  v_dot2_f32_bf16 v55, v19, s53, 0
  s_waitcnt vmcnt(13)
  v_dot2_f32_bf16 v48, v20, s52, v48
  v_dot2_f32_bf16 v49, v20, s53, v49
  v_dot2_f32_bf16 v50, v21, s52, v50
  v_dot2_f32_bf16 v51, v21, s53, v51
  s_waitcnt vmcnt(12)
  v_dot2_f32_bf16 v52, v22, s52, v52
  v_dot2_f32_bf16 v53, v22, s53, v53
  v_dot2_f32_bf16 v54, v23, s52, v54
  v_dot2_f32_bf16 v55, v23, s53, v55
  s_waitcnt vmcnt(11)
  v_dot2_f32_bf16 v48, v24, s52, v48
  v_dot2_f32_bf16 v49, v24, s53, v49
  v_dot2_f32_bf16 v50, v25, s52, v50
  v_dot2_f32_bf16 v51, v25, s53, v51
  s_waitcnt vmcnt(10)
  v_dot2_f32_bf16 v52, v26, s52, v52
  v_dot2_f32_bf16 v53, v26, s53, v53
  v_dot2_f32_bf16 v54, v27, s52, v54
  v_dot2_f32_bf16 v55, v27, s53, v55
  s_waitcnt vmcnt(9)
  v_dot2_f32_bf16 v48, v28, s52, v48
  v_dot2_f32_bf16 v49, v28, s53, v49
  v_dot2_f32_bf16 v50, v29, s52, v50
  v_dot2_f32_bf16 v51, v29, s53, v51
  s_waitcnt vmcnt(8)
  v_dot2_f32_bf16 v52, v30, s52, v52
  v_dot2_f32_bf16 v53, v30, s53, v53
  v_dot2_f32_bf16 v54, v31, s52, v54
  v_dot2_f32_bf16 v55, v31, s53, v55
  s_waitcnt vmcnt(7)
  v_dot2_f32_bf16 v48, v32, s52, v48
  v_dot2_f32_bf16 v49, v32, s53, v49
  v_dot2_f32_bf16 v50, v33, s52, v50
  v_dot2_f32_bf16 v51, v33, s53, v51
  s_waitcnt vmcnt(6)
  v_dot2_f32_bf16 v52, v34, s52, v52
  v_dot2_f32_bf16 v53, v34, s53, v53
  v_dot2_f32_bf16 v54, v35, s52, v54
  v_dot2_f32_bf16 v55, v35, s53, v55
  s_waitcnt vmcnt(5)
  v_dot2_f32_bf16 v48, v36, s52, v48
  v_dot2_f32_bf16 v49, v36, s53, v49
  v_dot2_f32_bf16 v50, v37, s52, v50
  v_dot2_f32_bf16 v51, v37, s53, v51
  s_waitcnt vmcnt(4)
  v_dot2_f32_bf16 v52, v38, s52, v52
  v_dot2_f32_bf16 v53, v38, s53, v53
  v_dot2_f32_bf16 v54, v39, s52, v54
  v_dot2_f32_bf16 v55, v39, s53, v55
  s_waitcnt vmcnt(3)
  v_dot2_f32_bf16 v48, v40, s52, v48
  v_dot2_f32_bf16 v49, v40, s53, v49
  v_dot2_f32_bf16 v50, v41, s52, v50
  v_dot2_f32_bf16 v51, v41, s53, v51
  s_waitcnt vmcnt(2)
  v_dot2_f32_bf16 v52, v42, s52, v52
  v_dot2_f32_bf16 v53, v42, s53, v53
  v_dot2_f32_bf16 v54, v43, s52, v54
  v_dot2_f32_bf16 v55, v43, s53, v55
  s_waitcnt vmcnt(1)
  v_dot2_f32_bf16 v48, v44, s52, v48
  v_dot2_f32_bf16 v49, v44, s53, v49
  v_dot2_f32_bf16 v50, v45, s52, v50
  v_dot2_f32_bf16 v51, v45, s53, v51
  s_waitcnt vmcnt(0)
  v_dot2_f32_bf16 v52, v46, s52, v52
  v_dot2_f32_bf16 v53, v46, s53, v53
  v_dot2_f32_bf16 v54, v47, s52, v54
  v_dot2_f32_bf16 v55, v47, s53, v55
  v_cvt_pk_bf16_f32 v16, v48, v49
  v_cvt_pk_bf16_f32 v17, v50, v51
  v_cvt_pk_bf16_f32 v18, v52, v53
  v_cvt_pk_bf16_f32 v19, v54, v55
  s_mul_i32 s50, s49, 81920
  s_add_u32 s51, s50, 40960
  buffer_store_dwordx2 v[16:17], v2, s[16:19], s50 offen
  buffer_store_dwordx2 v[18:19], v2, s[16:19], s51 offen
  s_add_u32 s49, s49, 25
  s_cmp_lt_u32 s49, 64
  s_cbranch_scc1 L_t_top
  s_endpgm
L_CHAIN:
  s_lshr_b32 s6, s5, 4
  s_lshl_b32 s46, s4, 1
  s_add_u32 s46, s46, s6
  s_and_b32 s47, s5, 15
  s_mov_b32 s60, 0xff00ff
  s_mov_b32 s61, 0xff00ff
  s_mov_b32 s62, 0xff00ff00
  s_mov_b32 s63, 0xff00ff00
  s_mov_b32 s64, 0x33333333
  s_mov_b32 s65, 0x33333333
  s_mov_b32 s66, 0xcccccccc
  s_mov_b32 s67, 0xcccccccc
  s_mov_b32 s70, 0x3e0293ee
  s_mov_b32 s72, 0x0
  s_mov_b32 s48, 0x0
  s_mov_b32 s56, 0x80000
  s_mul_i32 s78, s4, 0x4000
  s_add_u32 s78, s78, 0x210000
  s_mul_i32 s79, s46, 0x8000
  s_add_u32 s79, s79, 0x0
  v_lshlrev_b32 v9, 4, v1
  v_lshrrev_b32 v12, 4, v1
  v_and_b32 v13, 7, v1
  v_lshlrev_b32 v5, 7, v12
  v_lshl_add_u32 v5, v13, 4, v5
  v_mov_b32 v88, -1
  v_mov_b32 v89, -1
  v_mov_b32 v90, -1
  v_mov_b32 v91, -1
  s_cmp_lt_u32 s47, 4
  s_cbranch_scc1 L_QK
  s_cmp_lt_u32 s47, 6
  s_cbranch_scc1 L_VCU
  s_branch L_BCU
L_BCU:
  s_sub_u32 s36, s47, 6
  s_lshr_b32 s6, s5, 4
  s_mul_i32 s6, s6, 10
  s_add_u32 s37, s6, s36
  v_bfe_u32 v12, v1, 3, 1
  v_lshl_add_u32 v8, v12, 3, v5
  s_lshl_b32 s6, s37, 9
  v_add_u32 v8, s6, v8
  s_mov_b32 s20, s44
  s_mov_b32 s21, s45
  v_lshrrev_b32 v12, 3, v1
  v_mul_u32_u24 v12, 1280, v12
  v_and_b32 v13, 7, v1
  v_lshl_add_u32 v12, v13, 4, v12
  s_lshl_b32 s7, s46, 3
  s_add_u32 s7, s7, s3
  s_mul_i32 s7, s7, 81920
  s_lshl_b32 s6, s36, 7
  s_add_u32 s7, s7, s6
  s_lshl_b32 s6, s3, 13
  s_mov_b32 m0, s6
  s_add_u32 s6, s6, 1024
  buffer_load_dwordx4 v12, s[20:23], s7 offen lds
  s_add_u32 s7, s7, 10240
  s_mov_b32 m0, s6
  s_add_u32 s6, s6, 1024
  buffer_load_dwordx4 v12, s[20:23], s7 offen lds
  s_add_u32 s7, s7, 10240
  s_mov_b32 m0, s6
  s_add_u32 s6, s6, 1024
  buffer_load_dwordx4 v12, s[20:23], s7 offen lds
  s_add_u32 s7, s7, 10240
  s_mov_b32 m0, s6
  s_add_u32 s6, s6, 1024
  buffer_load_dwordx4 v12, s[20:23], s7 offen lds
  s_add_u32 s7, s7, 10240
  s_mov_b32 m0, s6
  s_add_u32 s6, s6, 1024
  buffer_load_dwordx4 v12, s[20:23], s7 offen lds
  s_add_u32 s7, s7, 10240
  s_mov_b32 m0, s6
  s_add_u32 s6, s6, 1024
  buffer_load_dwordx4 v12, s[20:23], s7 offen lds
  s_add_u32 s7, s7, 10240
  s_mov_b32 m0, s6
  s_add_u32 s6, s6, 1024
  buffer_load_dwordx4 v12, s[20:23], s7 offen lds
  s_add_u32 s7, s7, 10240
  s_mov_b32 m0, s6
  s_add_u32 s6, s6, 1024
  buffer_load_dwordx4 v12, s[20:23], s7 offen lds
  s_add_u32 s7, s7, 10240
  s_mov_b32 s20, s40
  s_mov_b32 s21, s41
  s_lshl_b32 s6, s36, 3
  s_add_u32 s6, s6, s3
  s_lshl_b32 s6, s6, 16
  s_lshl_b32 s7, s46, 10
  s_add_u32 s6, s6, s7
  v_lshrrev_b32 v12, 3, v1
  v_lshlrev_b32 v12, 13, v12
  v_and_b32 v13, 7, v1
  v_lshl_add_u32 v13, v13, 7, v12
  buffer_load_dword v93, v13, s[20:23], s6 offen
  s_mov_b32 s20, s42
  s_mov_b32 s21, s43
  v_bfe_u32 v13, v1, 1, 1
  v_lshl_add_u32 v12, v13, 9, v12
  v_and_b32 v13, 1, v1
  v_lshl_add_u32 v12, v13, 7, v12
  s_mov_b32 exec_lo, 0x0f0f0f0f
  s_mov_b32 exec_hi, 0x0f0f0f0f
  buffer_load_dword v94, v12, s[20:23], s6 offen offset:256
  s_mov_b64 exec, -1
  s_waitcnt vmcnt(2)
  s_barrier
  s_cmp_lt_u32 s3, 4
  s_cbranch_scc1 L_b_fin
  s_and_b32 s39, s3, 3
  v_lshrrev_b32 v12, 4, v1
  v_lshlrev_b32 v12, 3, v12
  v_bfe_u32 v13, v1, 2, 2
  v_add_u32 v12, v12, v13
  s_lshl_b32 s6, s39, 7
  v_add_u32 v12, s6, v12
  v_lshlrev_b32 v12, 7, v12
  v_and_b32 v13, 3, v1
  v_lshl_add_u32 v12, v13, 3, v12
  ds_read_b64_tr_b16 v[96:97], v12 offset:0
  ds_read_b64_tr_b16 v[98:99], v12 offset:512
  ds_read_b64_tr_b16 v[100:101], v12 offset:4096
  ds_read_b64_tr_b16 v[102:103], v12 offset:4608
  ds_read_b64_tr_b16 v[104:105], v12 offset:8192
  ds_read_b64_tr_b16 v[106:107], v12 offset:8704
  ds_read_b64_tr_b16 v[108:109], v12 offset:12288
  ds_read_b64_tr_b16 v[110:111], v12 offset:12800
  s_waitcnt lgkmcnt(0)
  ds_read_b64_tr_b16 v[112:113], v12 offset:32
  ds_read_b64_tr_b16 v[114:115], v12 offset:544
  ds_read_b64_tr_b16 v[116:117], v12 offset:4128
  ds_read_b64_tr_b16 v[118:119], v12 offset:4640
  ds_read_b64_tr_b16 v[120:121], v12 offset:8224
  ds_read_b64_tr_b16 v[122:123], v12 offset:8736
  ds_read_b64_tr_b16 v[124:125], v12 offset:12320
  ds_read_b64_tr_b16 v[126:127], v12 offset:12832
  s_waitcnt lgkmcnt(0)
  ds_read_b64_tr_b16 v[128:129], v12 offset:64
  ds_read_b64_tr_b16 v[130:131], v12 offset:576
  ds_read_b64_tr_b16 v[132:133], v12 offset:4160
  ds_read_b64_tr_b16 v[134:135], v12 offset:4672
  ds_read_b64_tr_b16 v[136:137], v12 offset:8256
  ds_read_b64_tr_b16 v[138:139], v12 offset:8768
  ds_read_b64_tr_b16 v[140:141], v12 offset:12352
  ds_read_b64_tr_b16 v[142:143], v12 offset:12864
  s_waitcnt lgkmcnt(0)
  ds_read_b64_tr_b16 v[144:145], v12 offset:96
  ds_read_b64_tr_b16 v[146:147], v12 offset:608
  ds_read_b64_tr_b16 v[148:149], v12 offset:4192
  ds_read_b64_tr_b16 v[150:151], v12 offset:4704
  ds_read_b64_tr_b16 v[152:153], v12 offset:8288
  ds_read_b64_tr_b16 v[154:155], v12 offset:8800
  ds_read_b64_tr_b16 v[156:157], v12 offset:12384
  ds_read_b64_tr_b16 v[158:159], v12 offset:12896
  s_waitcnt lgkmcnt(0)
  v_bfe_u32 v12, v1, 5, 1
  v_lshlrev_b32 v12, 4, v12
  v_bfe_u32 v13, v1, 4, 1
  v_lshl_add_u32 v12, v13, 2, v12
  v_bfe_u32 v13, v1, 2, 1
  v_add_u32 v12, v12, v13
  v_bfe_u32 v13, v1, 3, 1
  v_lshl_add_u32 v12, v13, 3, v12
  s_lshl_b32 s6, s39, 7
  v_add_u32 v12, s6, v12
  v_lshlrev_b32 v12, 7, v12
  v_and_b32 v13, 3, v1
  v_lshl_add_u32 v12, v13, 3, v12
  ds_read_b64_tr_b16 v[192:193], v12 offset:0
  ds_read_b64_tr_b16 v[194:195], v12 offset:256
  ds_read_b64_tr_b16 v[196:197], v12 offset:4096
  ds_read_b64_tr_b16 v[198:199], v12 offset:4352
  ds_read_b64_tr_b16 v[200:201], v12 offset:8192
  ds_read_b64_tr_b16 v[202:203], v12 offset:8448
  ds_read_b64_tr_b16 v[204:205], v12 offset:12288
  ds_read_b64_tr_b16 v[206:207], v12 offset:12544
  s_waitcnt lgkmcnt(0)
  ds_read_b64_tr_b16 v[208:209], v12 offset:32
  ds_read_b64_tr_b16 v[210:211], v12 offset:288
  ds_read_b64_tr_b16 v[212:213], v12 offset:4128
  ds_read_b64_tr_b16 v[214:215], v12 offset:4384
  ds_read_b64_tr_b16 v[216:217], v12 offset:8224
  ds_read_b64_tr_b16 v[218:219], v12 offset:8480
  ds_read_b64_tr_b16 v[220:221], v12 offset:12320
  ds_read_b64_tr_b16 v[222:223], v12 offset:12576
  s_waitcnt lgkmcnt(0)
  ds_read_b64_tr_b16 v[240:241], v12 offset:64
  ds_read_b64_tr_b16 v[242:243], v12 offset:320
  ds_read_b64_tr_b16 v[244:245], v12 offset:4160
  ds_read_b64_tr_b16 v[246:247], v12 offset:4416
  ds_read_b64_tr_b16 v[248:249], v12 offset:8256
  ds_read_b64_tr_b16 v[250:251], v12 offset:8512
  ds_read_b64_tr_b16 v[252:253], v12 offset:12352
  ds_read_b64_tr_b16 v[254:255], v12 offset:12608
  s_waitcnt lgkmcnt(0)
  ds_read_b64_tr_b16 v[72:73], v12 offset:96
  ds_read_b64_tr_b16 v[74:75], v12 offset:352
  ds_read_b64_tr_b16 v[76:77], v12 offset:4192
  ds_read_b64_tr_b16 v[78:79], v12 offset:4448
  ds_read_b64_tr_b16 v[80:81], v12 offset:8288
  ds_read_b64_tr_b16 v[82:83], v12 offset:8544
  ds_read_b64_tr_b16 v[84:85], v12 offset:12384
  ds_read_b64_tr_b16 v[86:87], v12 offset:12640
  s_waitcnt lgkmcnt(0)
  v_mov_b32 v12, 0x4444
  v_mov_b32 v13, 0xeeee
  v_cndmask_b32 v4, v12, v13, s[62:63]
  v_lshlrev_b32 v12, 5, v1
  s_mov_b32 s59, 65536
L_rdy_45:
  buffer_load_dword v13, v12, s[12:15], 0 offen offset:4 sc1
  s_waitcnt vmcnt(0)
  v_readlane_b32 s57, v13, 0
  v_readlane_b32 s58, v13, 1
  s_add_u32 s57, s57, s58
  v_readlane_b32 s58, v13, 2
  s_add_u32 s57, s57, s58
  v_readlane_b32 s58, v13, 3
  s_add_u32 s57, s57, s58
  v_readlane_b32 s58, v13, 4
  s_add_u32 s57, s57, s58
  v_readlane_b32 s58, v13, 5
  s_add_u32 s57, s57, s58
  v_readlane_b32 s58, v13, 6
  s_add_u32 s57, s57, s58
  v_readlane_b32 s58, v13, 7
  s_add_u32 s57, s57, s58
  s_cmp_ge_u32 s57, 256
  s_cbranch_scc1 L_rdyd_46
  s_sleep 8
  s_sub_u32 s59, s59, 1
  s_cmp_lg_u32 s59, 0
  s_cbranch_scc1 L_rdy_45
  s_endpgm
L_rdyd_46:
  s_mov_b32 s6, 65536
  v_mov_b32 v15, 8
L_sd_47:
  buffer_load_dwordx3 v[12:14], v15, s[12:15], 0 offen sc1
  s_waitcnt vmcnt(0)
  v_readfirstlane_b32 s73, v14
  s_cmp_ge_u32 s73, 0
  s_cbranch_scc1 L_se_48
  s_sleep 8
  s_sub_u32 s6, s6, 1
  s_cmp_lg_u32 s6, 0
  s_cbranch_scc1 L_sd_47
  s_endpgm
L_se_48:
  v_readfirstlane_b32 s73, v12
  s_cmp_gt_i32 s73, 0
  s_cselect_b32 s73, 0x2000, 0
  v_readfirstlane_b32 s74, v13
  s_lshl_b32 s57, s46, 2
  s_add_u32 s57, s57, s39
  s_add_u32 s57, s57, 64
  v_and_b32 v95, 7, v1
  s_lshl_b32 s6, s57, 3
  v_add_u32 v95, s6, v95
  v_lshlrev_b32 v95, 2, v95
  v_add_u32 v95, 0x280000, v95
  s_lshl_b32 s32, s57, 13
  s_add_u32 s32, s32, 0x400000
  s_lshl_b32 s6, s39, 10
  s_add_u32 s6, s6, 24576
  v_add_u32 v10, s6, v9
  s_lshl_b32 s6, s39, 2
  s_add_u32 s6, s6, 16384
  v_and_b32 v12, 15, v1
  v_lshlrev_b32 v12, 4, v12
  v_bfe_u32 v13, v1, 4, 1
  v_lshl_add_u32 v12, v13, 9, v12
  v_lshrrev_b32 v13, 5, v1
  v_lshl_add_u32 v12, v13, 8, v12
  v_add_u32 v6, s6, v12
  s_barrier
  s_setprio 1
  s_mul_i32 s6, s36, 7
  v_add_u32 v12, s6, v1
  v_min_u32 v12, 63, v12
  v_lshlrev_b32 v11, 7, v12
  s_mul_i32 s6, s36, 13
  v_add_u32 v12, s6, v1
  v_min_u32 v12, 127, v12
  v_lshrrev_b32 v13, 6, v12
  v_and_b32 v12, 63, v12
  v_lshlrev_b32 v12, 7, v12
  v_lshl_add_u32 v3, v13, 18, v12
  s_add_u32 s59, s48, 0
  s_min_u32 s59, s59, 63
  s_lshr_b32 s59, s59, 1
  s_cmp_gt_u32 s72, s59
  s_cbranch_scc0 L_y0_poll
L_y0_go:
  s_add_u32 s6, s32, 4096
  buffer_load_dwordx4 v[160:163], v9, s[8:11], s32 offen offset:0 sc1
  buffer_load_dwordx4 v[164:167], v9, s[8:11], s32 offen offset:1024 sc1
  buffer_load_dwordx4 v[168:171], v9, s[8:11], s32 offen offset:2048 sc1
  buffer_load_dwordx4 v[172:175], v9, s[8:11], s32 offen offset:3072 sc1
  buffer_load_dwordx4 v[176:179], v9, s[8:11], s6 offen offset:0 sc1
  buffer_load_dwordx4 v[180:183], v9, s[8:11], s6 offen offset:1024 sc1
  buffer_load_dwordx4 v[184:187], v9, s[8:11], s6 offen offset:2048 sc1
  buffer_load_dwordx4 v[188:191], v9, s[8:11], s6 offen offset:3072 sc1
  s_add_u32 s32, s32, 786432
  s_waitcnt vmcnt(0)
  s_lshl_b32 s6, s39, 11
  s_add_u32 s6, s6, 40960
  v_add_u32 v7, s6, v9
  s_and_b32 s6, s39, 1
  s_lshl_b32 s38, s6, 10
  s_add_u32 s6, s38, 49152
  v_add_u32 v8, s6, v9
L_y_top:
  s_and_b32 s57, s48, 3
  s_lshl_b32 s50, s57, 16
  s_lshl_b32 s51, s57, 18
  s_add_u32 s50, s50, s78
  s_add_u32 s51, s51, s79
  s_mov_b32 s56, 524288
  s_lshl_b32 s53, s39, 11
  s_add_u32 s54, s48, 3
  s_and_b32 s54, s54, 3
  s_lshl_b32 s54, s54, 18
  s_add_u32 s54, s54, s79
  s_add_u32 s37, s54, s38
  s_add_u32 s37, s37, 0x6000
  s_add_u32 s54, s54, s53
  s_add_u32 s54, s54, 0x4000
  s_add_u32 s53, s53, s51
  s_cmp_eq_u32 s48, 64
  s_cbranch_scc1 L_y_by
  v_mfma_f32_16x16x32_bf16 v[16:19], v[160:163], v[96:99], 0
  v_mfma_f32_16x16x32_bf16 v[24:27], v[160:163], v[112:115], 0
  v_mfma_f32_16x16x32_bf16 v[32:35], v[160:163], v[128:131], 0
  v_mfma_f32_16x16x32_bf16 v[40:43], v[160:163], v[144:147], 0
  v_mfma_f32_16x16x32_bf16 v[20:23], v[164:167], v[96:99], 0
  v_mfma_f32_16x16x32_bf16 v[28:31], v[164:167], v[112:115], 0
  v_mfma_f32_16x16x32_bf16 v[36:39], v[164:167], v[128:131], 0
  v_mfma_f32_16x16x32_bf16 v[44:47], v[164:167], v[144:147], 0
  v_mfma_f32_16x16x32_bf16 v[16:19], v[168:171], v[100:103], v[16:19]
  v_mfma_f32_16x16x32_bf16 v[24:27], v[168:171], v[116:119], v[24:27]
  v_mfma_f32_16x16x32_bf16 v[32:35], v[168:171], v[132:135], v[32:35]
  v_mfma_f32_16x16x32_bf16 v[40:43], v[168:171], v[148:151], v[40:43]
  v_mfma_f32_16x16x32_bf16 v[20:23], v[172:175], v[100:103], v[20:23]
  v_mfma_f32_16x16x32_bf16 v[28:31], v[172:175], v[116:119], v[28:31]
  v_mfma_f32_16x16x32_bf16 v[36:39], v[172:175], v[132:135], v[36:39]
  v_mfma_f32_16x16x32_bf16 v[44:47], v[172:175], v[148:151], v[44:47]
  v_mfma_f32_16x16x32_bf16 v[16:19], v[176:179], v[104:107], v[16:19]
  v_mfma_f32_16x16x32_bf16 v[24:27], v[176:179], v[120:123], v[24:27]
  v_mfma_f32_16x16x32_bf16 v[32:35], v[176:179], v[136:139], v[32:35]
  v_mfma_f32_16x16x32_bf16 v[40:43], v[176:179], v[152:155], v[40:43]
  v_mfma_f32_16x16x32_bf16 v[20:23], v[180:183], v[104:107], v[20:23]
  v_mfma_f32_16x16x32_bf16 v[28:31], v[180:183], v[120:123], v[28:31]
  v_mfma_f32_16x16x32_bf16 v[36:39], v[180:183], v[136:139], v[36:39]
  v_mfma_f32_16x16x32_bf16 v[44:47], v[180:183], v[152:155], v[44:47]
  v_mfma_f32_16x16x32_bf16 v[16:19], v[184:187], v[108:111], v[16:19]
  v_mfma_f32_16x16x32_bf16 v[24:27], v[184:187], v[124:127], v[24:27]
  v_mfma_f32_16x16x32_bf16 v[32:35], v[184:187], v[140:143], v[32:35]
  v_mfma_f32_16x16x32_bf16 v[40:43], v[184:187], v[156:159], v[40:43]
  v_mfma_f32_16x16x32_bf16 v[20:23], v[188:191], v[108:111], v[20:23]
  v_mfma_f32_16x16x32_bf16 v[28:31], v[188:191], v[124:127], v[28:31]
  v_mfma_f32_16x16x32_bf16 v[36:39], v[188:191], v[140:143], v[36:39]
  v_mfma_f32_16x16x32_bf16 v[44:47], v[188:191], v[156:159], v[44:47]
  s_nop 0
  v_cvt_pk_bf16_f32 v224, v16, v17
  v_cvt_pk_bf16_f32 v225, v18, v19
  s_nop 1
  v_cvt_pk_bf16_f32 v226, v20, v21
  v_cvt_pk_bf16_f32 v227, v22, v23
  v_cvt_pk_bf16_f32 v228, v24, v25
  v_cvt_pk_bf16_f32 v229, v26, v27
  v_cvt_pk_bf16_f32 v230, v28, v29
  v_cvt_pk_bf16_f32 v231, v30, v31
  v_cvt_pk_bf16_f32 v232, v32, v33
  v_cvt_pk_bf16_f32 v233, v34, v35
  v_cvt_pk_bf16_f32 v234, v36, v37
  v_cvt_pk_bf16_f32 v235, v38, v39
  v_cvt_pk_bf16_f32 v236, v40, v41
  v_cvt_pk_bf16_f32 v237, v42, v43
  v_cvt_pk_bf16_f32 v238, v44, v45
  v_cvt_pk_bf16_f32 v239, v46, v47
  ds_write_b128 v10, v[224:227] offset:0
  ds_write_b128 v10, v[228:231] offset:4096
  ds_write_b128 v10, v[232:235] offset:8192
  ds_write_b128 v10, v[236:239] offset:12288
  s_waitcnt lgkmcnt(0)
L_y_by:
  s_barrier
  s_cmp_lt_u32 s48, 63
  s_cbranch_scc0 L_y_nv
  s_add_u32 s59, s48, 1
  s_min_u32 s59, s59, 63
  s_lshr_b32 s59, s59, 1
  s_cmp_gt_u32 s72, s59
  s_cbranch_scc0 L_y1_poll
L_y1_go:
  s_add_u32 s6, s32, 4096
  buffer_load_dwordx4 v[160:163], v9, s[8:11], s32 offen offset:0 sc1
  buffer_load_dwordx4 v[164:167], v9, s[8:11], s32 offen offset:1024 sc1
  buffer_load_dwordx4 v[168:171], v9, s[8:11], s32 offen offset:2048 sc1
  buffer_load_dwordx4 v[172:175], v9, s[8:11], s32 offen offset:3072 sc1
  buffer_load_dwordx4 v[176:179], v9, s[8:11], s6 offen offset:0 sc1
  buffer_load_dwordx4 v[180:183], v9, s[8:11], s6 offen offset:1024 sc1
  buffer_load_dwordx4 v[184:187], v9, s[8:11], s6 offen offset:2048 sc1
  buffer_load_dwordx4 v[188:191], v9, s[8:11], s6 offen offset:3072 sc1
  s_add_u32 s32, s32, 786432
L_y_nv:
  s_cmp_eq_u32 s48, 0
  s_cbranch_scc1 L_y_bx
L_y_px:
  buffer_load_dwordx4 v[32:35], v9, s[8:11], s54 offen sc1
  buffer_load_dwordx4 v[36:39], v9, s[8:11], s54 offen offset:1024 sc1
  buffer_load_dwordx4 v[40:43], v9, s[8:11], s37 offen sc1
  s_waitcnt vmcnt(0)
  v_max3_u32 v14, v35, v39, v40
  v_max3_u32 v14, v14, v41, v42
  v_max_u32 v14, v14, v43
  v_cmp_eq_u32 vcc, -1, v14
  s_cbranch_vccnz L_y_pxr
  ds_write_b128 v7, v[32:35]
  ds_write_b128 v7, v[36:39] offset:1024
  ds_write_b128 v8, v[40:43]
  s_waitcnt lgkmcnt(0)
L_y_bx:
  s_barrier
  s_cmp_eq_u32 s48, 64
  s_cbranch_scc1 L_END
  s_sleep 4
  v_mov_b32 v16, 0
  v_mov_b32 v17, 0
  v_mov_b32 v18, 0
  v_mov_b32 v19, 0
  v_mov_b32 v20, 0
  v_mov_b32 v21, 0
  v_mov_b32 v22, 0
  v_mov_b32 v23, 0
  v_mov_b32 v24, 0
  v_mov_b32 v25, 0
  v_mov_b32 v26, 0
  v_mov_b32 v27, 0
  v_mov_b32 v28, 0
  v_mov_b32 v29, 0
  v_mov_b32 v30, 0
  v_mov_b32 v31, 0
  buffer_load_dwordx4 v[48:51], v9, s[8:11], s53 offen offset:0 sc1
  buffer_load_dwordx4 v[52:55], v9, s[8:11], s53 offen offset:1024 sc1
  s_nop 15
  s_nop 15
L_y_g3:
  buffer_load_dwordx4 v[56:59], v9, s[8:11], s53 offen offset:0 sc1
  buffer_load_dwordx4 v[60:63], v9, s[8:11], s53 offen offset:1024 sc1
  s_waitcnt vmcnt(2)
  v_max_u32 v14, v51, v55
  v_cmp_eq_u32 vcc, -1, v14
  s_cbranch_vccz L_y_a
  buffer_load_dwordx4 v[48:51], v9, s[8:11], s53 offen offset:0 sc1
  buffer_load_dwordx4 v[52:55], v9, s[8:11], s53 offen offset:1024 sc1
  s_waitcnt vmcnt(2)
  v_max_u32 v14, v59, v63
  v_cmp_eq_u32 vcc, -1, v14
  s_cbranch_vccz L_y_b
  s_sub_u32 s56, s56, 1
  s_cmp_lg_u32 s56, 0
  s_cbranch_scc1 L_y_g3
  s_endpgm
L_y_b:
  s_barrier
  v_smfmac_f32_16x16x64_bf16 v[16:19], v[56:59], v[192:199], v4
  v_smfmac_f32_16x16x64_bf16 v[20:23], v[56:59], v[208:215], v4
  v_smfmac_f32_16x16x64_bf16 v[24:27], v[56:59], v[240:247], v4
  v_smfmac_f32_16x16x64_bf16 v[28:31], v[56:59], v[72:79], v4
  v_smfmac_f32_16x16x64_bf16 v[16:19], v[60:63], v[200:207], v4
  v_smfmac_f32_16x16x64_bf16 v[20:23], v[60:63], v[216:223], v4
  v_smfmac_f32_16x16x64_bf16 v[24:27], v[60:63], v[248:255], v4
  v_smfmac_f32_16x16x64_bf16 v[28:31], v[60:63], v[80:87], v4
  s_branch L_y_u
L_y_a:
  s_barrier
  v_smfmac_f32_16x16x64_bf16 v[16:19], v[48:51], v[192:199], v4
  v_smfmac_f32_16x16x64_bf16 v[20:23], v[48:51], v[208:215], v4
  v_smfmac_f32_16x16x64_bf16 v[24:27], v[48:51], v[240:247], v4
  v_smfmac_f32_16x16x64_bf16 v[28:31], v[48:51], v[72:79], v4
  v_smfmac_f32_16x16x64_bf16 v[16:19], v[52:55], v[200:207], v4
  v_smfmac_f32_16x16x64_bf16 v[20:23], v[52:55], v[216:223], v4
  v_smfmac_f32_16x16x64_bf16 v[24:27], v[52:55], v[248:255], v4
  v_smfmac_f32_16x16x64_bf16 v[28:31], v[52:55], v[80:87], v4
L_y_u:
  s_nop 4
  v_permlane32_swap_b32 v16, v18
  v_permlane32_swap_b32 v17, v19
  v_pk_add_f32 v[16:17], v[16:17], v[18:19]
  v_cvt_pk_bf16_f32 v16, v16, v17
  ds_write_b32 v6, v16 offset:0
  v_permlane32_swap_b32 v20, v22
  v_permlane32_swap_b32 v21, v23
  v_pk_add_f32 v[20:21], v[20:21], v[22:23]
  v_cvt_pk_bf16_f32 v20, v20, v21
  ds_write_b32 v6, v20 offset:1024
  v_permlane32_swap_b32 v24, v26
  v_permlane32_swap_b32 v25, v27
  v_pk_add_f32 v[24:25], v[24:25], v[26:27]
  v_cvt_pk_bf16_f32 v24, v24, v25
  ds_write_b32 v6, v24 offset:2048
  v_permlane32_swap_b32 v28, v30
  v_permlane32_swap_b32 v29, v31
  v_pk_add_f32 v[28:29], v[28:29], v[30:31]
  v_cvt_pk_bf16_f32 v28, v28, v29
  ds_write_b32 v6, v28 offset:3072
  s_add_u32 s48, s48, 1
  s_waitcnt lgkmcnt(0)
  s_barrier
  s_barrier
  s_branch L_y_top
L_y_pxr:
  s_sub_u32 s56, s56, 1
  s_cmp_lg_u32 s56, 0
  s_cbranch_scc1 L_y_px
  s_endpgm
L_y0_poll:
  buffer_load_dword v14, v95, s[8:11], 0 offen sc1
  s_waitcnt vmcnt(0)
  v_min_u32 v14, v14, v14 row_ror:8 row_mask:0xf bank_mask:0xf
  s_nop 1
  v_min_u32 v14, v14, v14 row_ror:4 row_mask:0xf bank_mask:0xf
  s_nop 1
  v_min_u32 v14, v14, v14 row_ror:2 row_mask:0xf bank_mask:0xf
  s_nop 1
  v_min_u32 v14, v14, v14 row_ror:1 row_mask:0xf bank_mask:0xf
  s_nop 0
  v_readfirstlane_b32 s72, v14
  s_cmp_gt_u32 s72, s59
  s_cbranch_scc1 L_y0_go
  s_sleep 2
  s_sub_u32 s56, s56, 1
  s_cmp_lg_u32 s56, 0
  s_cbranch_scc1 L_y0_poll
  s_endpgm
L_y1_poll:
  buffer_load_dword v14, v95, s[8:11], 0 offen sc1
  s_waitcnt vmcnt(0)
  v_min_u32 v14, v14, v14 row_ror:8 row_mask:0xf bank_mask:0xf
  s_nop 1
  v_min_u32 v14, v14, v14 row_ror:4 row_mask:0xf bank_mask:0xf
  s_nop 1
  v_min_u32 v14, v14, v14 row_ror:2 row_mask:0xf bank_mask:0xf
  s_nop 1
  v_min_u32 v14, v14, v14 row_ror:1 row_mask:0xf bank_mask:0xf
  s_nop 0
  v_readfirstlane_b32 s72, v14
  s_cmp_gt_u32 s72, s59
  s_cbranch_scc1 L_y1_go
  s_sleep 2
  s_sub_u32 s56, s56, 1
  s_cmp_lg_u32 s56, 0
  s_cbranch_scc1 L_y1_poll
  s_endpgm
L_b_fin:
  v_lshlrev_b32 v12, 5, v1
  s_mov_b32 s59, 65536
L_rdy_49:
  buffer_load_dword v13, v12, s[12:15], 0 offen offset:4 sc1
  s_waitcnt vmcnt(0)
  v_readlane_b32 s57, v13, 0
  v_readlane_b32 s58, v13, 1
  s_add_u32 s57, s57, s58
  v_readlane_b32 s58, v13, 2
  s_add_u32 s57, s57, s58
  v_readlane_b32 s58, v13, 3
  s_add_u32 s57, s57, s58
  v_readlane_b32 s58, v13, 4
  s_add_u32 s57, s57, s58
  v_readlane_b32 s58, v13, 5
  s_add_u32 s57, s57, s58
  v_readlane_b32 s58, v13, 6
  s_add_u32 s57, s57, s58
  v_readlane_b32 s58, v13, 7
  s_add_u32 s57, s57, s58
  s_cmp_ge_u32 s57, 256
  s_cbranch_scc1 L_rdyd_50
  s_sleep 8
  s_sub_u32 s59, s59, 1
  s_cmp_lg_u32 s59, 0
  s_cbranch_scc1 L_rdy_49
  s_endpgm
L_rdyd_50:
  s_mov_b32 s6, 65536
  v_mov_b32 v15, 8
L_sd_51:
  buffer_load_dwordx3 v[12:14], v15, s[12:15], 0 offen sc1
  s_waitcnt vmcnt(0)
  v_readfirstlane_b32 s73, v14
  s_cmp_ge_u32 s73, 2
  s_cbranch_scc1 L_se_52
  s_sleep 8
  s_sub_u32 s6, s6, 1
  s_cmp_lg_u32 s6, 0
  s_cbranch_scc1 L_sd_51
  s_endpgm
L_se_52:
  v_readfirstlane_b32 s73, v12
  s_cmp_gt_i32 s73, 0
  s_cselect_b32 s73, 0x2000, 0
  v_readfirstlane_b32 s74, v13
  s_lshl_b32 s6, s3, 12
  s_add_u32 s6, s6, 24576
  v_add_u32 v10, s6, v9
  s_lshl_b32 s6, s3, 10
  s_add_u32 s6, s6, 16384
  v_add_u32 v6, s6, v9
  v_lshrrev_b32 v7, 1, v5
  s_lshl_b32 s28, s36, 14
  s_lshl_b32 s6, s46, 9
  s_add_u32 s28, s28, s6
  s_lshr_b32 s6, s3, 1
  s_lshl_b32 s6, s6, 12
  s_add_u32 s28, s28, s6
  s_and_b32 s6, s3, 1
  s_lshl_b32 s6, s6, 8
  s_add_u32 s28, s28, s6
  s_add_u32 s28, s28, 0x8400000
  s_lshr_b32 s31, s37, 1
  s_lshl_b32 s31, s31, 14
  s_and_b32 s6, s37, 1
  s_lshl_b32 s6, s6, 12
  s_add_u32 s31, s31, s6
  s_add_u32 s31, s31, 0x8400000
  v_lshlrev_b32 v3, 3, v1
  s_mov_b32 s37, 0x3f80
  s_mov_b32 s38, 0x3f800000
  v_bfe_u32 v12, v1, 3, 1
  v_lshl_add_u32 v11, v12, 9, v5
  s_and_b32 s6, s3, 1
  s_lshl_b32 s6, s6, 8
  v_lshlrev_b32 v166, 2, v1
  v_add_u32 v166, s6, v166
  v_lshrrev_b32 v12, 5, v1
  v_lshlrev_b32 v12, 7, v12
  v_bfe_u32 v13, v1, 1, 3
  v_lshl_add_u32 v12, v13, 4, v12
  v_bfe_u32 v13, v1, 4, 1
  v_lshl_add_u32 v12, v13, 3, v12
  v_and_b32 v13, 1, v1
  v_lshl_add_u32 v12, v13, 2, v12
  v_readfirstlane_b32 s7, v8
  s_add_u32 s6, s6, s7
  v_add_u32 v167, s6, v12
  s_lshl_b32 s57, s36, 3
  s_add_u32 s57, s57, s46
  s_lshr_b32 s29, s57, 6
  s_lshl_b32 s29, s29, 14
  s_and_b32 s6, s57, 63
  s_lshl_b32 s6, s6, 7
  s_add_u32 s29, s29, s6
  s_xor_b32 s6, s73, 0x2000
  s_add_u32 s29, s29, s6
  s_add_u32 s29, s29, 0x290000
  s_lshl_b32 s40, s36, 2
  s_add_u32 s40, s40, s3
  s_lshl_b32 s40, s40, 3
  s_add_u32 s40, s40, s46
  s_lshl_b32 s40, s40, 10
  s_add_u32 s40, s40, 0x53b0000
  s_barrier
  s_setprio 3
  s_cmp_lg_u32 s74, 0
  s_cbranch_scc1 L_f_slow
L_f_top:
  s_and_b32 s57, s48, 3
  s_lshl_b32 s50, s57, 16
  s_lshl_b32 s51, s57, 18
  s_add_u32 s50, s50, s78
  s_add_u32 s51, s51, s79
  s_mov_b32 s56, 524288
  s_add_u32 s53, s51, 0x2000
  s_lshl_b32 s57, s57, 18
  s_add_u32 s57, s57, s73
  s_add_u32 s55, s57, s28
  s_add_u32 s30, s57, s31
  s_add_u32 s57, s48, 1
  s_and_b32 s57, s57, 3
  s_lshl_b32 s54, s57, 16
  s_add_u32 s54, s54, s78
  s_add_u32 s35, s48, 3
  s_and_b32 s35, s35, 3
  s_lshl_b32 s35, s35, 16
  s_add_u32 s35, s35, s78
  v_mov_b32 v170, v16
  v_mov_b32 v171, v17
  v_mov_b32 v172, v18
  v_mov_b32 v173, v19
  v_mov_b32 v174, v20
  v_mov_b32 v175, v21
  v_mov_b32 v176, v22
  v_mov_b32 v177, v23
  v_mov_b32 v178, v24
  v_mov_b32 v179, v25
  v_mov_b32 v180, v26
  v_mov_b32 v181, v27
  v_mov_b32 v182, v28
  v_mov_b32 v183, v29
  v_mov_b32 v184, v30
  v_mov_b32 v185, v31
  v_mov_b32 v186, v32
  v_mov_b32 v187, v33
  v_mov_b32 v188, v34
  v_mov_b32 v189, v35
  s_barrier
  s_cmp_eq_u32 s3, 1
  s_cbranch_scc0 L_f_nr
  s_sleep 10
  buffer_store_dwordx2 v[88:89], v8, s[8:11], s35 offen
L_f_nr:
  ds_read_b128 v[16:19], v10 offset:0
  ds_read_b128 v[20:23], v10 offset:1024
  ds_read_b128 v[24:27], v10 offset:2048
  ds_read_b128 v[28:31], v10 offset:3072
  s_barrier
  v_add_u32 v12, 40960, v9
  ds_read_b128 v[192:195], v12 offset:0
  ds_read_b128 v[196:199], v12 offset:1024
  ds_read_b128 v[200:203], v12 offset:2048
  ds_read_b128 v[204:207], v12 offset:3072
  ds_read_b128 v[208:211], v12 offset:4096
  ds_read_b128 v[212:215], v12 offset:5120
  ds_read_b128 v[216:219], v12 offset:6144
  ds_read_b128 v[220:223], v12 offset:7168
  ds_read_b128 v[224:227], v12 offset:8192
  ds_read_b128 v[228:231], v12 offset:9216
  s_waitcnt lgkmcnt(0)
  v_mfma_f32_16x16x32_bf16 v[232:235], v[170:173], v[192:195], 0
  v_mfma_f32_16x16x32_bf16 v[236:239], v[170:173], v[196:199], 0
  v_mfma_f32_16x16x32_bf16 v[232:235], v[174:177], v[200:203], v[232:235]
  v_mfma_f32_16x16x32_bf16 v[236:239], v[174:177], v[204:207], v[236:239]
  v_mfma_f32_16x16x32_bf16 v[232:235], v[178:181], v[208:211], v[232:235]
  v_mfma_f32_16x16x32_bf16 v[236:239], v[178:181], v[212:215], v[236:239]
  v_mfma_f32_16x16x32_bf16 v[232:235], v[182:185], v[216:219], v[232:235]
  v_mfma_f32_16x16x32_bf16 v[236:239], v[182:185], v[220:223], v[236:239]
  v_mfma_f32_16x16x32_bf16 v[232:235], v[186:189], v[224:227], v[232:235]
  v_mfma_f32_16x16x32_bf16 v[236:239], v[186:189], v[228:231], v[236:239]
  s_nop 6
  v_cvt_pk_bf16_f32 v240, v232, v233
  v_cvt_pk_bf16_f32 v241, v234, v235
  v_cvt_pk_bf16_f32 v242, v236, v237
  v_cvt_pk_bf16_f32 v243, v238, v239
  s_cmp_ge_u32 s48, 63
  s_cbranch_scc1 L_f_end
  s_barrier
  buffer_load_dwordx4 v[40:43], v11, s[8:11], s53 offen offset:0 sc1
  buffer_load_dwordx4 v[44:47], v11, s[8:11], s53 offen offset:1024 sc1
  buffer_load_dwordx4 v[48:51], v5, s[8:11], s53 offen offset:2048 sc1
  s_nop 11
  buffer_load_dwordx4 v[96:99], v11, s[8:11], s53 offen offset:0 sc1
  buffer_load_dwordx4 v[100:103], v11, s[8:11], s53 offen offset:1024 sc1
  buffer_load_dwordx4 v[104:107], v5, s[8:11], s53 offen offset:2048 sc1
  s_waitcnt lgkmcnt(0)
  s_waitcnt vmcnt(5)
  v_mfma_f32_16x16x32_bf16 v[64:67], v[16:19], v[40:43], 0
  v_mfma_f32_16x16x32_bf16 v[68:71], v[20:23], v[40:43], 0
  s_waitcnt vmcnt(4)
  v_mfma_f32_16x16x32_bf16 v[64:67], v[24:27], v[44:47], v[64:67]
  v_max3_u32 v14, v41, v43, v45
  v_mfma_f32_16x16x32_bf16 v[68:71], v[28:31], v[44:47], v[68:71]
  s_waitcnt vmcnt(3)
  v_max3_u32 v15, v47, v48, v49
  v_max3_u32 v14, v14, v50, v51
  v_max_u32 v14, v14, v15
  v_cmp_eq_u32 vcc, -1, v14
  s_cbranch_vccnz L_f_re
L_f_oka:
  s_barrier
  ds_read_b128 v[32:35], v6
  s_waitcnt lgkmcnt(0)
  v_mfma_f32_16x16x32_bf16 v[64:67], v[32:35], v[48:51], v[64:67]
L_f_ok:
  s_nop 7
  v_add_f32 v64, v68, v64 row_ror:8 row_mask:0xf bank_mask:0xf
  v_add_f32 v65, v69, v65 row_ror:8 row_mask:0xf bank_mask:0xf
  v_add_f32 v66, v70, v66 row_ror:8 row_mask:0xf bank_mask:0xf
  v_add_f32 v67, v71, v67 row_ror:8 row_mask:0xf bank_mask:0xf
  s_mov_b64 exec, s[60:61]
  v_cvt_pk_bf16_f32 v64, v64, v65
  v_cvt_pk_bf16_f32 v65, v66, v67
  v_min_u32 v64, -2, v64
  v_min_u32 v65, -2, v65
L_f_st:
  buffer_store_dwordx2 v[64:65], v7, s[8:11], s55 offen sc1
  s_mov_b64 exec, -1
  buffer_store_dwordx2 v[240:241], v3, s[8:11], s40 offen offset:0 sc1
  buffer_store_dwordx2 v[242:243], v3, s[8:11], s40 offen offset:512 sc1
  s_add_u32 s40, s40, 327680
  s_barrier
  s_cmp_eq_u32 s3, 0
  s_cbranch_scc0 L_f_nfl
  s_and_b32 s57, s48, 7
  s_cmp_ge_u32 s48, 61
  s_cselect_b32 s57, 0, s57
  s_cmp_eq_u32 s57, 0
  s_cbranch_scc0 L_f_nfl
  s_sub_u32 s57, s48, 1
  s_max_i32 s57, s57, 0
  v_mov_b32 v14, s57
  v_mov_b32 v15, 0
  s_mov_b64 exec, 1
  buffer_store_dword v14, v15, s[8:11], s29 offen sc1
  s_mov_b64 exec, -1
L_f_nfl:
  s_cmp_ge_u32 s3, 2
  s_cbranch_scc0 L_f_b4
  s_sleep 5
  buffer_load_dword v128, v166, s[8:11], s30 offen offset:0 sc1
  buffer_load_dword v129, v166, s[8:11], s30 offen offset:512 sc1
  buffer_load_dword v130, v166, s[8:11], s30 offen offset:1024 sc1
  buffer_load_dword v131, v166, s[8:11], s30 offen offset:1536 sc1
  buffer_load_dword v132, v166, s[8:11], s30 offen offset:2048 sc1
  buffer_load_dword v133, v166, s[8:11], s30 offen offset:2560 sc1
  buffer_load_dword v134, v166, s[8:11], s30 offen offset:3072 sc1
  buffer_load_dword v135, v166, s[8:11], s30 offen offset:3584 sc1
  s_waitcnt vmcnt(6)
  v_dot2_f32_bf16 v160, v128, s37, 0
  v_dot2_f32_bf16 v161, v128, s38, 0
  v_dot2_f32_bf16 v162, v129, s37, 0
  v_dot2_f32_bf16 v163, v129, s38, 0
  s_waitcnt vmcnt(4)
  v_dot2_f32_bf16 v160, v130, s37, v160
  v_dot2_f32_bf16 v161, v130, s38, v161
  v_dot2_f32_bf16 v162, v131, s37, v162
  v_dot2_f32_bf16 v163, v131, s38, v163
  s_waitcnt vmcnt(2)
  v_dot2_f32_bf16 v160, v132, s37, v160
  v_dot2_f32_bf16 v161, v132, s38, v161
  v_dot2_f32_bf16 v162, v133, s37, v162
  v_dot2_f32_bf16 v163, v133, s38, v163
  s_waitcnt vmcnt(0)
  v_dot2_f32_bf16 v160, v134, s37, v160
  v_dot2_f32_bf16 v161, v134, s38, v161
  v_dot2_f32_bf16 v162, v135, s37, v162
  v_dot2_f32_bf16 v163, v135, s38, v163
  s_nop 2
  v_pk_add_f32 v[160:161], v[160:161], v[162:163]
  v_cmp_u_f32 vcc, v160, v161
  v_cvt_pk_bf16_f32 v164, v160, v161
  v_min_u32 v164, -2, v164
  s_cbranch_vccnz L_gm_re
L_gm_ok:
  buffer_store_dword v164, v167, s[8:11], s54 offen
L_f_b4:
  s_add_u32 s48, s48, 1
  s_branch L_f_top
L_f_end:
  buffer_store_dwordx2 v[240:241], v3, s[8:11], s40 offen offset:0 sc1
  buffer_store_dwordx2 v[242:243], v3, s[8:11], s40 offen offset:512 sc1
  s_add_u32 s40, s40, 327680
  s_cmp_eq_u32 s48, 64
  s_cbranch_scc1 L_f_fin
  s_barrier
  s_barrier
  ds_read_b128 v[32:35], v6
  s_waitcnt vmcnt(0) lgkmcnt(0)
  s_barrier
  s_add_u32 s48, s48, 1
  s_branch L_f_top
L_f_fin:
  s_waitcnt vmcnt(0)
  s_barrier
  s_cmp_eq_u32 s3, 0
  s_cbranch_scc0 L_END
  v_mov_b32 v14, 64
  v_mov_b32 v15, 0
  s_mov_b64 exec, 1
  buffer_store_dword v14, v15, s[8:11], s29 offen sc1
  s_mov_b64 exec, -1
  s_endpgm
L_f_re:
L_f_re2:
  buffer_load_dwordx4 v[40:43], v11, s[8:11], s53 offen offset:0 sc1
  buffer_load_dwordx4 v[44:47], v11, s[8:11], s53 offen offset:1024 sc1
  buffer_load_dwordx4 v[48:51], v5, s[8:11], s53 offen offset:2048 sc1
  s_waitcnt vmcnt(5)
  v_mfma_f32_16x16x32_bf16 v[64:67], v[16:19], v[96:99], 0
  v_mfma_f32_16x16x32_bf16 v[68:71], v[20:23], v[96:99], 0
  s_waitcnt vmcnt(4)
  v_mfma_f32_16x16x32_bf16 v[64:67], v[24:27], v[100:103], v[64:67]
  v_max3_u32 v14, v97, v99, v101
  v_mfma_f32_16x16x32_bf16 v[68:71], v[28:31], v[100:103], v[68:71]
  s_waitcnt vmcnt(3)
  v_max3_u32 v15, v103, v104, v105
  v_max3_u32 v14, v14, v106, v107
  v_max_u32 v14, v14, v15
  v_cmp_eq_u32 vcc, -1, v14
  s_cbranch_vccz L_f_okb
  buffer_load_dwordx4 v[96:99], v11, s[8:11], s53 offen offset:0 sc1
  buffer_load_dwordx4 v[100:103], v11, s[8:11], s53 offen offset:1024 sc1
  buffer_load_dwordx4 v[104:107], v5, s[8:11], s53 offen offset:2048 sc1
  s_waitcnt vmcnt(5)
  v_mfma_f32_16x16x32_bf16 v[64:67], v[16:19], v[40:43], 0
  v_mfma_f32_16x16x32_bf16 v[68:71], v[20:23], v[40:43], 0
  s_waitcnt vmcnt(4)
  v_mfma_f32_16x16x32_bf16 v[64:67], v[24:27], v[44:47], v[64:67]
  v_max3_u32 v14, v41, v43, v45
  v_mfma_f32_16x16x32_bf16 v[68:71], v[28:31], v[44:47], v[68:71]
  s_waitcnt vmcnt(3)
  v_max3_u32 v15, v47, v48, v49
  v_max3_u32 v14, v14, v50, v51
  v_max_u32 v14, v14, v15
  v_cmp_eq_u32 vcc, -1, v14
  s_cbranch_vccz L_f_oka
  s_sub_u32 s56, s56, 1
  s_cmp_lg_u32 s56, 0
  s_cbranch_scc1 L_f_re2
  s_endpgm
L_f_okb:
  s_barrier
  ds_read_b128 v[32:35], v6
  s_waitcnt lgkmcnt(0)
  v_mfma_f32_16x16x32_bf16 v[64:67], v[32:35], v[104:107], v[64:67]
  s_branch L_f_ok
L_gm_re:
  buffer_load_dword v144, v166, s[8:11], s30 offen offset:0 sc1
  buffer_load_dword v145, v166, s[8:11], s30 offen offset:512 sc1
  buffer_load_dword v146, v166, s[8:11], s30 offen offset:1024 sc1
  buffer_load_dword v147, v166, s[8:11], s30 offen offset:1536 sc1
  buffer_load_dword v148, v166, s[8:11], s30 offen offset:2048 sc1
  buffer_load_dword v149, v166, s[8:11], s30 offen offset:2560 sc1
  buffer_load_dword v150, v166, s[8:11], s30 offen offset:3072 sc1
  buffer_load_dword v151, v166, s[8:11], s30 offen offset:3584 sc1
  s_nop 15
  s_nop 15
L_gm_re2:
  buffer_load_dword v128, v166, s[8:11], s30 offen offset:0 sc1
  buffer_load_dword v129, v166, s[8:11], s30 offen offset:512 sc1
  buffer_load_dword v130, v166, s[8:11], s30 offen offset:1024 sc1
  buffer_load_dword v131, v166, s[8:11], s30 offen offset:1536 sc1
  buffer_load_dword v132, v166, s[8:11], s30 offen offset:2048 sc1
  buffer_load_dword v133, v166, s[8:11], s30 offen offset:2560 sc1
  buffer_load_dword v134, v166, s[8:11], s30 offen offset:3072 sc1
  buffer_load_dword v135, v166, s[8:11], s30 offen offset:3584 sc1
  s_waitcnt vmcnt(14)
  v_dot2_f32_bf16 v160, v144, s37, 0
  v_dot2_f32_bf16 v161, v144, s38, 0
  v_dot2_f32_bf16 v162, v145, s37, 0
  v_dot2_f32_bf16 v163, v145, s38, 0
  s_waitcnt vmcnt(12)
  v_dot2_f32_bf16 v160, v146, s37, v160
  v_dot2_f32_bf16 v161, v146, s38, v161
  v_dot2_f32_bf16 v162, v147, s37, v162
  v_dot2_f32_bf16 v163, v147, s38, v163
  s_waitcnt vmcnt(10)
  v_dot2_f32_bf16 v160, v148, s37, v160
  v_dot2_f32_bf16 v161, v148, s38, v161
  v_dot2_f32_bf16 v162, v149, s37, v162
  v_dot2_f32_bf16 v163, v149, s38, v163
  s_waitcnt vmcnt(8)
  v_dot2_f32_bf16 v160, v150, s37, v160
  v_dot2_f32_bf16 v161, v150, s38, v161
  v_dot2_f32_bf16 v162, v151, s37, v162
  v_dot2_f32_bf16 v163, v151, s38, v163
  s_nop 2
  v_pk_add_f32 v[160:161], v[160:161], v[162:163]
  v_cmp_u_f32 vcc, v160, v161
  v_cvt_pk_bf16_f32 v164, v160, v161
  v_min_u32 v164, -2, v164
  s_cbranch_vccz L_gm_ok
  buffer_load_dword v144, v166, s[8:11], s30 offen offset:0 sc1
  buffer_load_dword v145, v166, s[8:11], s30 offen offset:512 sc1
  buffer_load_dword v146, v166, s[8:11], s30 offen offset:1024 sc1
  buffer_load_dword v147, v166, s[8:11], s30 offen offset:1536 sc1
  buffer_load_dword v148, v166, s[8:11], s30 offen offset:2048 sc1
  buffer_load_dword v149, v166, s[8:11], s30 offen offset:2560 sc1
  buffer_load_dword v150, v166, s[8:11], s30 offen offset:3072 sc1
  buffer_load_dword v151, v166, s[8:11], s30 offen offset:3584 sc1
  s_waitcnt vmcnt(14)
  v_dot2_f32_bf16 v160, v128, s37, 0
  v_dot2_f32_bf16 v161, v128, s38, 0
  v_dot2_f32_bf16 v162, v129, s37, 0
  v_dot2_f32_bf16 v163, v129, s38, 0
  s_waitcnt vmcnt(12)
  v_dot2_f32_bf16 v160, v130, s37, v160
  v_dot2_f32_bf16 v161, v130, s38, v161
  v_dot2_f32_bf16 v162, v131, s37, v162
  v_dot2_f32_bf16 v163, v131, s38, v163
  s_waitcnt vmcnt(10)
  v_dot2_f32_bf16 v160, v132, s37, v160
  v_dot2_f32_bf16 v161, v132, s38, v161
  v_dot2_f32_bf16 v162, v133, s37, v162
  v_dot2_f32_bf16 v163, v133, s38, v163
  s_waitcnt vmcnt(8)
  v_dot2_f32_bf16 v160, v134, s37, v160
  v_dot2_f32_bf16 v161, v134, s38, v161
  v_dot2_f32_bf16 v162, v135, s37, v162
  v_dot2_f32_bf16 v163, v135, s38, v163
  s_nop 2
  v_pk_add_f32 v[160:161], v[160:161], v[162:163]
  v_cmp_u_f32 vcc, v160, v161
  v_cvt_pk_bf16_f32 v164, v160, v161
  v_min_u32 v164, -2, v164
  s_cbranch_vccz L_gm_ok
  s_and_b32 s57, s56, 15
  s_cmp_eq_u32 s57, 1
  s_cbranch_scc0 L_gm_re3
  v_max3_u32 v14, v128, v129, v130
  v_max3_u32 v15, v131, v132, v133
  v_max3_u32 v14, v14, v134, v135
  v_max_u32 v14, v14, v15
  v_cmp_eq_u32 vcc, -1, v14
  s_cbranch_vccz L_gm_ok
L_gm_re3:
  s_sub_u32 s56, s56, 1
  s_cmp_lg_u32 s56, 0
  s_cbranch_scc1 L_gm_re2
  s_endpgm
L_f_slow:
L_f_top_S:
  s_and_b32 s57, s48, 3
  s_lshl_b32 s50, s57, 16
  s_lshl_b32 s51, s57, 18
  s_add_u32 s50, s50, s78
  s_add_u32 s51, s51, s79
  s_mov_b32 s56, 524288
  s_add_u32 s53, s51, 0x2000
  s_lshl_b32 s57, s57, 18
  s_add_u32 s57, s57, s73
  s_add_u32 s55, s57, s28
  s_add_u32 s30, s57, s31
  s_add_u32 s57, s48, 1
  s_and_b32 s57, s57, 3
  s_lshl_b32 s54, s57, 16
  s_add_u32 s54, s54, s78
  s_add_u32 s35, s48, 3
  s_and_b32 s35, s35, 3
  s_lshl_b32 s35, s35, 16
  s_add_u32 s35, s35, s78
  v_mov_b32 v170, v16
  v_mov_b32 v171, v17
  v_mov_b32 v172, v18
  v_mov_b32 v173, v19
  v_mov_b32 v174, v20
  v_mov_b32 v175, v21
  v_mov_b32 v176, v22
  v_mov_b32 v177, v23
  v_mov_b32 v178, v24
  v_mov_b32 v179, v25
  v_mov_b32 v180, v26
  v_mov_b32 v181, v27
  v_mov_b32 v182, v28
  v_mov_b32 v183, v29
  v_mov_b32 v184, v30
  v_mov_b32 v185, v31
  v_mov_b32 v186, v32
  v_mov_b32 v187, v33
  v_mov_b32 v188, v34
  v_mov_b32 v189, v35
  s_barrier
  s_cmp_eq_u32 s3, 1
  s_cbranch_scc0 L_f_nr_S
  s_sleep 10
  buffer_store_dwordx2 v[88:89], v8, s[8:11], s35 offen sc1
L_f_nr_S:
  ds_read_b128 v[16:19], v10 offset:0
  ds_read_b128 v[20:23], v10 offset:1024
  ds_read_b128 v[24:27], v10 offset:2048
  ds_read_b128 v[28:31], v10 offset:3072
  s_barrier
  v_add_u32 v12, 40960, v9
  ds_read_b128 v[192:195], v12 offset:0
  ds_read_b128 v[196:199], v12 offset:1024
  ds_read_b128 v[200:203], v12 offset:2048
  ds_read_b128 v[204:207], v12 offset:3072
  ds_read_b128 v[208:211], v12 offset:4096
  ds_read_b128 v[212:215], v12 offset:5120
  ds_read_b128 v[216:219], v12 offset:6144
  ds_read_b128 v[220:223], v12 offset:7168
  ds_read_b128 v[224:227], v12 offset:8192
  ds_read_b128 v[228:231], v12 offset:9216
  s_waitcnt lgkmcnt(0)
  v_mfma_f32_16x16x32_bf16 v[232:235], v[170:173], v[192:195], 0
  v_mfma_f32_16x16x32_bf16 v[236:239], v[170:173], v[196:199], 0
  v_mfma_f32_16x16x32_bf16 v[232:235], v[174:177], v[200:203], v[232:235]
  v_mfma_f32_16x16x32_bf16 v[236:239], v[174:177], v[204:207], v[236:239]
  v_mfma_f32_16x16x32_bf16 v[232:235], v[178:181], v[208:211], v[232:235]
  v_mfma_f32_16x16x32_bf16 v[236:239], v[178:181], v[212:215], v[236:239]
  v_mfma_f32_16x16x32_bf16 v[232:235], v[182:185], v[216:219], v[232:235]
  v_mfma_f32_16x16x32_bf16 v[236:239], v[182:185], v[220:223], v[236:239]
  v_mfma_f32_16x16x32_bf16 v[232:235], v[186:189], v[224:227], v[232:235]
  v_mfma_f32_16x16x32_bf16 v[236:239], v[186:189], v[228:231], v[236:239]
  s_nop 6
  v_cvt_pk_bf16_f32 v240, v232, v233
  v_cvt_pk_bf16_f32 v241, v234, v235
  v_cvt_pk_bf16_f32 v242, v236, v237
  v_cvt_pk_bf16_f32 v243, v238, v239
  s_cmp_ge_u32 s48, 63
  s_cbranch_scc1 L_f_end_S
  s_barrier
  buffer_load_dwordx4 v[40:43], v11, s[8:11], s53 offen offset:0 sc1
  buffer_load_dwordx4 v[44:47], v11, s[8:11], s53 offen offset:1024 sc1
  buffer_load_dwordx4 v[48:51], v5, s[8:11], s53 offen offset:2048 sc1
  s_nop 11
  buffer_load_dwordx4 v[96:99], v11, s[8:11], s53 offen offset:0 sc1
  buffer_load_dwordx4 v[100:103], v11, s[8:11], s53 offen offset:1024 sc1
  buffer_load_dwordx4 v[104:107], v5, s[8:11], s53 offen offset:2048 sc1
  s_waitcnt lgkmcnt(0)
  s_waitcnt vmcnt(5)
  v_mfma_f32_16x16x32_bf16 v[64:67], v[16:19], v[40:43], 0
  v_mfma_f32_16x16x32_bf16 v[68:71], v[20:23], v[40:43], 0
  s_waitcnt vmcnt(4)
  v_mfma_f32_16x16x32_bf16 v[64:67], v[24:27], v[44:47], v[64:67]
  v_max3_u32 v14, v41, v43, v45
  v_mfma_f32_16x16x32_bf16 v[68:71], v[28:31], v[44:47], v[68:71]
  s_waitcnt vmcnt(3)
  v_max3_u32 v15, v47, v48, v49
  v_max3_u32 v14, v14, v50, v51
  v_max_u32 v14, v14, v15
  v_cmp_eq_u32 vcc, -1, v14
  s_cbranch_vccnz L_f_re_S
L_f_oka_S:
  s_barrier
  ds_read_b128 v[32:35], v6
  s_waitcnt lgkmcnt(0)
  v_mfma_f32_16x16x32_bf16 v[64:67], v[32:35], v[48:51], v[64:67]
L_f_ok_S:
  s_nop 7
  v_add_f32 v64, v68, v64 row_ror:8 row_mask:0xf bank_mask:0xf
  v_add_f32 v65, v69, v65 row_ror:8 row_mask:0xf bank_mask:0xf
  v_add_f32 v66, v70, v66 row_ror:8 row_mask:0xf bank_mask:0xf
  v_add_f32 v67, v71, v67 row_ror:8 row_mask:0xf bank_mask:0xf
  s_mov_b64 exec, s[60:61]
  v_cvt_pk_bf16_f32 v64, v64, v65
  v_cvt_pk_bf16_f32 v65, v66, v67
  v_min_u32 v64, -2, v64
  v_min_u32 v65, -2, v65
L_f_st_S:
  buffer_store_dwordx2 v[64:65], v7, s[8:11], s55 offen sc1
  s_mov_b64 exec, -1
  buffer_store_dwordx2 v[240:241], v3, s[8:11], s40 offen offset:0 sc1
  buffer_store_dwordx2 v[242:243], v3, s[8:11], s40 offen offset:512 sc1
  s_add_u32 s40, s40, 327680
  s_barrier
  s_cmp_eq_u32 s3, 0
  s_cbranch_scc0 L_f_nfl_S
  s_and_b32 s57, s48, 7
  s_cmp_ge_u32 s48, 61
  s_cselect_b32 s57, 0, s57
  s_cmp_eq_u32 s57, 0
  s_cbranch_scc0 L_f_nfl_S
  s_sub_u32 s57, s48, 1
  s_max_i32 s57, s57, 0
  v_mov_b32 v14, s57
  v_mov_b32 v15, 0
  s_mov_b64 exec, 1
  buffer_store_dword v14, v15, s[8:11], s29 offen sc1
  s_mov_b64 exec, -1
L_f_nfl_S:
  s_cmp_ge_u32 s3, 2
  s_cbranch_scc0 L_f_b4_S
  s_sleep 5
  buffer_load_dword v128, v166, s[8:11], s30 offen offset:0 sc1
  buffer_load_dword v129, v166, s[8:11], s30 offen offset:512 sc1
  buffer_load_dword v130, v166, s[8:11], s30 offen offset:1024 sc1
  buffer_load_dword v131, v166, s[8:11], s30 offen offset:1536 sc1
  buffer_load_dword v132, v166, s[8:11], s30 offen offset:2048 sc1
  buffer_load_dword v133, v166, s[8:11], s30 offen offset:2560 sc1
  buffer_load_dword v134, v166, s[8:11], s30 offen offset:3072 sc1
  buffer_load_dword v135, v166, s[8:11], s30 offen offset:3584 sc1
  s_waitcnt vmcnt(6)
  v_dot2_f32_bf16 v160, v128, s37, 0
  v_dot2_f32_bf16 v161, v128, s38, 0
  v_dot2_f32_bf16 v162, v129, s37, 0
  v_dot2_f32_bf16 v163, v129, s38, 0
  s_waitcnt vmcnt(4)
  v_dot2_f32_bf16 v160, v130, s37, v160
  v_dot2_f32_bf16 v161, v130, s38, v161
  v_dot2_f32_bf16 v162, v131, s37, v162
  v_dot2_f32_bf16 v163, v131, s38, v163
  s_waitcnt vmcnt(2)
  v_dot2_f32_bf16 v160, v132, s37, v160
  v_dot2_f32_bf16 v161, v132, s38, v161
  v_dot2_f32_bf16 v162, v133, s37, v162
  v_dot2_f32_bf16 v163, v133, s38, v163
  s_waitcnt vmcnt(0)
  v_dot2_f32_bf16 v160, v134, s37, v160
  v_dot2_f32_bf16 v161, v134, s38, v161
  v_dot2_f32_bf16 v162, v135, s37, v162
  v_dot2_f32_bf16 v163, v135, s38, v163
  s_nop 2
  v_pk_add_f32 v[160:161], v[160:161], v[162:163]
  v_cmp_u_f32 vcc, v160, v161
  v_cvt_pk_bf16_f32 v164, v160, v161
  v_min_u32 v164, -2, v164
  s_cbranch_vccnz L_gm_re_S
L_gm_ok_S:
  buffer_store_dword v164, v167, s[8:11], s54 offen sc1
L_f_b4_S:
  s_add_u32 s48, s48, 1
  s_branch L_f_top_S
L_f_end_S:
  buffer_store_dwordx2 v[240:241], v3, s[8:11], s40 offen offset:0 sc1
  buffer_store_dwordx2 v[242:243], v3, s[8:11], s40 offen offset:512 sc1
  s_add_u32 s40, s40, 327680
  s_cmp_eq_u32 s48, 64
  s_cbranch_scc1 L_f_fin_S
  s_barrier
  s_barrier
  ds_read_b128 v[32:35], v6
  s_waitcnt vmcnt(0) lgkmcnt(0)
  s_barrier
  s_add_u32 s48, s48, 1
  s_branch L_f_top_S
L_f_fin_S:
  s_waitcnt vmcnt(0)
  s_barrier
  s_cmp_eq_u32 s3, 0
  s_cbranch_scc0 L_END
  v_mov_b32 v14, 64
  v_mov_b32 v15, 0
  s_mov_b64 exec, 1
  buffer_store_dword v14, v15, s[8:11], s29 offen sc1
  s_mov_b64 exec, -1
  s_endpgm
L_f_re_S:
L_f_re2_S:
  buffer_load_dwordx4 v[40:43], v11, s[8:11], s53 offen offset:0 sc1
  buffer_load_dwordx4 v[44:47], v11, s[8:11], s53 offen offset:1024 sc1
  buffer_load_dwordx4 v[48:51], v5, s[8:11], s53 offen offset:2048 sc1
  s_waitcnt vmcnt(5)
  v_mfma_f32_16x16x32_bf16 v[64:67], v[16:19], v[96:99], 0
  v_mfma_f32_16x16x32_bf16 v[68:71], v[20:23], v[96:99], 0
  s_waitcnt vmcnt(4)
  v_mfma_f32_16x16x32_bf16 v[64:67], v[24:27], v[100:103], v[64:67]
  v_max3_u32 v14, v97, v99, v101
  v_mfma_f32_16x16x32_bf16 v[68:71], v[28:31], v[100:103], v[68:71]
  s_waitcnt vmcnt(3)
  v_max3_u32 v15, v103, v104, v105
  v_max3_u32 v14, v14, v106, v107
  v_max_u32 v14, v14, v15
  v_cmp_eq_u32 vcc, -1, v14
  s_cbranch_vccz L_f_okb_S
  buffer_load_dwordx4 v[96:99], v11, s[8:11], s53 offen offset:0 sc1
  buffer_load_dwordx4 v[100:103], v11, s[8:11], s53 offen offset:1024 sc1
  buffer_load_dwordx4 v[104:107], v5, s[8:11], s53 offen offset:2048 sc1
  s_waitcnt vmcnt(5)
  v_mfma_f32_16x16x32_bf16 v[64:67], v[16:19], v[40:43], 0
  v_mfma_f32_16x16x32_bf16 v[68:71], v[20:23], v[40:43], 0
  s_waitcnt vmcnt(4)
  v_mfma_f32_16x16x32_bf16 v[64:67], v[24:27], v[44:47], v[64:67]
  v_max3_u32 v14, v41, v43, v45
  v_mfma_f32_16x16x32_bf16 v[68:71], v[28:31], v[44:47], v[68:71]
  s_waitcnt vmcnt(3)
  v_max3_u32 v15, v47, v48, v49
  v_max3_u32 v14, v14, v50, v51
  v_max_u32 v14, v14, v15
  v_cmp_eq_u32 vcc, -1, v14
  s_cbranch_vccz L_f_oka_S
  s_sub_u32 s56, s56, 1
  s_cmp_lg_u32 s56, 0
  s_cbranch_scc1 L_f_re2_S
  s_endpgm
L_f_okb_S:
  s_barrier
  ds_read_b128 v[32:35], v6
  s_waitcnt lgkmcnt(0)
  v_mfma_f32_16x16x32_bf16 v[64:67], v[32:35], v[104:107], v[64:67]
  s_branch L_f_ok_S
L_gm_re_S:
  buffer_load_dword v144, v166, s[8:11], s30 offen offset:0 sc1
  buffer_load_dword v145, v166, s[8:11], s30 offen offset:512 sc1
  buffer_load_dword v146, v166, s[8:11], s30 offen offset:1024 sc1
  buffer_load_dword v147, v166, s[8:11], s30 offen offset:1536 sc1
  buffer_load_dword v148, v166, s[8:11], s30 offen offset:2048 sc1
  buffer_load_dword v149, v166, s[8:11], s30 offen offset:2560 sc1
  buffer_load_dword v150, v166, s[8:11], s30 offen offset:3072 sc1
  buffer_load_dword v151, v166, s[8:11], s30 offen offset:3584 sc1
  s_nop 15
  s_nop 15
L_gm_re2_S:
  buffer_load_dword v128, v166, s[8:11], s30 offen offset:0 sc1
  buffer_load_dword v129, v166, s[8:11], s30 offen offset:512 sc1
  buffer_load_dword v130, v166, s[8:11], s30 offen offset:1024 sc1
  buffer_load_dword v131, v166, s[8:11], s30 offen offset:1536 sc1
  buffer_load_dword v132, v166, s[8:11], s30 offen offset:2048 sc1
  buffer_load_dword v133, v166, s[8:11], s30 offen offset:2560 sc1
  buffer_load_dword v134, v166, s[8:11], s30 offen offset:3072 sc1
  buffer_load_dword v135, v166, s[8:11], s30 offen offset:3584 sc1
  s_waitcnt vmcnt(14)
  v_dot2_f32_bf16 v160, v144, s37, 0
  v_dot2_f32_bf16 v161, v144, s38, 0
  v_dot2_f32_bf16 v162, v145, s37, 0
  v_dot2_f32_bf16 v163, v145, s38, 0
  s_waitcnt vmcnt(12)
  v_dot2_f32_bf16 v160, v146, s37, v160
  v_dot2_f32_bf16 v161, v146, s38, v161
  v_dot2_f32_bf16 v162, v147, s37, v162
  v_dot2_f32_bf16 v163, v147, s38, v163
  s_waitcnt vmcnt(10)
  v_dot2_f32_bf16 v160, v148, s37, v160
  v_dot2_f32_bf16 v161, v148, s38, v161
  v_dot2_f32_bf16 v162, v149, s37, v162
  v_dot2_f32_bf16 v163, v149, s38, v163
  s_waitcnt vmcnt(8)
  v_dot2_f32_bf16 v160, v150, s37, v160
  v_dot2_f32_bf16 v161, v150, s38, v161
  v_dot2_f32_bf16 v162, v151, s37, v162
  v_dot2_f32_bf16 v163, v151, s38, v163
  s_nop 2
  v_pk_add_f32 v[160:161], v[160:161], v[162:163]
  v_cmp_u_f32 vcc, v160, v161
  v_cvt_pk_bf16_f32 v164, v160, v161
  v_min_u32 v164, -2, v164
  s_cbranch_vccz L_gm_ok_S
  buffer_load_dword v144, v166, s[8:11], s30 offen offset:0 sc1
  buffer_load_dword v145, v166, s[8:11], s30 offen offset:512 sc1
  buffer_load_dword v146, v166, s[8:11], s30 offen offset:1024 sc1
  buffer_load_dword v147, v166, s[8:11], s30 offen offset:1536 sc1
  buffer_load_dword v148, v166, s[8:11], s30 offen offset:2048 sc1
  buffer_load_dword v149, v166, s[8:11], s30 offen offset:2560 sc1
  buffer_load_dword v150, v166, s[8:11], s30 offen offset:3072 sc1
  buffer_load_dword v151, v166, s[8:11], s30 offen offset:3584 sc1
  s_waitcnt vmcnt(14)
  v_dot2_f32_bf16 v160, v128, s37, 0
  v_dot2_f32_bf16 v161, v128, s38, 0
  v_dot2_f32_bf16 v162, v129, s37, 0
  v_dot2_f32_bf16 v163, v129, s38, 0
  s_waitcnt vmcnt(12)
  v_dot2_f32_bf16 v160, v130, s37, v160
  v_dot2_f32_bf16 v161, v130, s38, v161
  v_dot2_f32_bf16 v162, v131, s37, v162
  v_dot2_f32_bf16 v163, v131, s38, v163
  s_waitcnt vmcnt(10)
  v_dot2_f32_bf16 v160, v132, s37, v160
  v_dot2_f32_bf16 v161, v132, s38, v161
  v_dot2_f32_bf16 v162, v133, s37, v162
  v_dot2_f32_bf16 v163, v133, s38, v163
  s_waitcnt vmcnt(8)
  v_dot2_f32_bf16 v160, v134, s37, v160
  v_dot2_f32_bf16 v161, v134, s38, v161
  v_dot2_f32_bf16 v162, v135, s37, v162
  v_dot2_f32_bf16 v163, v135, s38, v163
  s_nop 2
  v_pk_add_f32 v[160:161], v[160:161], v[162:163]
  v_cmp_u_f32 vcc, v160, v161
  v_cvt_pk_bf16_f32 v164, v160, v161
  v_min_u32 v164, -2, v164
  s_cbranch_vccz L_gm_ok_S
  s_and_b32 s57, s56, 15
  s_cmp_eq_u32 s57, 1
  s_cbranch_scc0 L_gm_re3_S
  v_max3_u32 v14, v128, v129, v130
  v_max3_u32 v15, v131, v132, v133
  v_max3_u32 v14, v14, v134, v135
  v_max_u32 v14, v14, v15
  v_cmp_eq_u32 vcc, -1, v14
  s_cbranch_vccz L_gm_ok_S
L_gm_re3_S:
  s_sub_u32 s56, s56, 1
  s_cmp_lg_u32 s56, 0
  s_cbranch_scc1 L_gm_re2_S
  s_endpgm
L_QK:
  s_lshl_b32 s49, s46, 2
  s_add_u32 s49, s49, s47
  s_lshl_b32 s58, s49, 8
  v_lshrrev_b32 v12, 4, v1
  v_lshlrev_b32 v13, 13, v12
  v_and_b32 v12, 1, v12
  v_lshlrev_b32 v12, 1, v12
  v_and_b32 v20, 15, v1
  v_xor_b32 v12, v12, v20
  v_xor_b32 v20, 0, v12
  v_lshl_add_u32 v16, v20, 4, v13
  v_xor_b32 v20, 8, v12
  v_lshl_add_u32 v17, v20, 4, v13
  v_xor_b32 v20, 4, v12
  v_lshl_add_u32 v18, v20, 4, v13
  v_xor_b32 v20, 12, v12
  v_lshl_add_u32 v19, v20, 4, v13
  v_bfe_u32 v12, v1, 5, 1
  v_lshlrev_b32 v12, 4, v12
  v_bfe_u32 v13, v1, 4, 1
  v_lshl_add_u32 v12, v13, 2, v12
  v_lshlrev_b32 v22, 2, v13
  v_bfe_u32 v13, v1, 2, 1
  v_add_u32 v12, v12, v13
  v_add_u32 v22, v22, v13
  v_bfe_u32 v13, v1, 3, 1
  v_lshl_add_u32 v12, v13, 3, v12
  v_lshl_add_u32 v22, v13, 1, v22
  v_lshlrev_b32 v12, 8, v12
  v_and_b32 v13, 3, v1
  v_lshl_add_u32 v21, v13, 3, v12
  s_mul_i32 s6, s3, 20480
  s_mul_i32 s7, s3, 655360
  s_add_u32 s7, s7, s58
  s_add_u32 s59, s7, 0
  s_mov_b32 m0, s6
  s_add_u32 s6, s6, 1024
  buffer_load_dwordx4 v16, s[20:23], s7 offen lds
  s_add_u32 s7, s7, 32768
  s_mov_b32 m0, s6
  s_add_u32 s6, s6, 1024
  buffer_load_dwordx4 v17, s[20:23], s7 offen lds
  s_add_u32 s7, s7, 32768
  s_mov_b32 m0, s6
  s_add_u32 s6, s6, 1024
  buffer_load_dwordx4 v18, s[20:23], s7 offen lds
  s_add_u32 s7, s7, 32768
  s_mov_b32 m0, s6
  s_add_u32 s6, s6, 1024
  buffer_load_dwordx4 v19, s[20:23], s7 offen lds
  s_add_u32 s7, s7, 32768
  s_mov_b32 m0, s6
  s_add_u32 s6, s6, 1024
  buffer_load_dwordx4 v16, s[20:23], s7 offen lds
  s_add_u32 s7, s7, 32768
  s_mov_b32 m0, s6
  s_add_u32 s6, s6, 1024
  buffer_load_dwordx4 v17, s[20:23], s7 offen lds
  s_add_u32 s7, s7, 32768
  s_mov_b32 m0, s6
  s_add_u32 s6, s6, 1024
  buffer_load_dwordx4 v18, s[20:23], s7 offen lds
  s_add_u32 s7, s7, 32768
  s_mov_b32 m0, s6
  s_add_u32 s6, s6, 1024
  buffer_load_dwordx4 v19, s[20:23], s7 offen lds
  s_add_u32 s7, s7, 32768
  s_mov_b32 m0, s6
  s_add_u32 s6, s6, 1024
  buffer_load_dwordx4 v16, s[20:23], s7 offen lds
  s_add_u32 s7, s7, 32768
  s_mov_b32 m0, s6
  s_add_u32 s6, s6, 1024
  buffer_load_dwordx4 v17, s[20:23], s7 offen lds
  s_add_u32 s7, s7, 32768
  s_mov_b32 m0, s6
  s_add_u32 s6, s6, 1024
  buffer_load_dwordx4 v18, s[20:23], s7 offen lds
  s_add_u32 s7, s7, 32768
  s_mov_b32 m0, s6
  s_add_u32 s6, s6, 1024
  buffer_load_dwordx4 v19, s[20:23], s7 offen lds
  s_add_u32 s7, s7, 32768
  s_mov_b32 m0, s6
  s_add_u32 s6, s6, 1024
  buffer_load_dwordx4 v16, s[20:23], s7 offen lds
  s_add_u32 s7, s7, 32768
  s_mov_b32 m0, s6
  s_add_u32 s6, s6, 1024
  buffer_load_dwordx4 v17, s[20:23], s7 offen lds
  s_add_u32 s7, s7, 32768
  s_mov_b32 m0, s6
  s_add_u32 s6, s6, 1024
  buffer_load_dwordx4 v18, s[20:23], s7 offen lds
  s_add_u32 s7, s7, 32768
  s_mov_b32 m0, s6
  s_add_u32 s6, s6, 1024
  buffer_load_dwordx4 v19, s[20:23], s7 offen lds
  s_add_u32 s7, s7, 32768
  s_mov_b32 m0, s6
  s_add_u32 s6, s6, 1024
  buffer_load_dwordx4 v16, s[20:23], s7 offen lds
  s_add_u32 s7, s7, 32768
  s_mov_b32 m0, s6
  s_add_u32 s6, s6, 1024
  buffer_load_dwordx4 v17, s[20:23], s7 offen lds
  s_add_u32 s7, s7, 32768
  s_mov_b32 m0, s6
  s_add_u32 s6, s6, 1024
  buffer_load_dwordx4 v18, s[20:23], s7 offen lds
  s_add_u32 s7, s7, 32768
  s_mov_b32 m0, s6
  s_add_u32 s6, s6, 1024
  buffer_load_dwordx4 v19, s[20:23], s7 offen lds
  s_add_u32 s7, s7, 32768
  s_mov_b32 s20, s40
  s_mov_b32 s21, s41
  buffer_load_dwordx4 v[176:179], v16, s[20:23], s59 offen
  s_add_u32 s59, s59, 32768
  buffer_load_dwordx4 v[180:183], v17, s[20:23], s59 offen
  s_add_u32 s59, s59, 32768
  buffer_load_dwordx4 v[184:187], v18, s[20:23], s59 offen
  s_add_u32 s59, s59, 32768
  buffer_load_dwordx4 v[188:191], v19, s[20:23], s59 offen
  s_add_u32 s59, s59, 32768
  buffer_load_dwordx4 v[192:195], v16, s[20:23], s59 offen
  s_add_u32 s59, s59, 32768
  buffer_load_dwordx4 v[196:199], v17, s[20:23], s59 offen
  s_add_u32 s59, s59, 32768
  buffer_load_dwordx4 v[200:203], v18, s[20:23], s59 offen
  s_add_u32 s59, s59, 32768
  buffer_load_dwordx4 v[204:207], v19, s[20:23], s59 offen
  s_add_u32 s59, s59, 32768
  buffer_load_dwordx4 v[208:211], v16, s[20:23], s59 offen
  s_add_u32 s59, s59, 32768
  buffer_load_dwordx4 v[212:215], v17, s[20:23], s59 offen
  s_add_u32 s59, s59, 32768
  buffer_load_dwordx4 v[216:219], v18, s[20:23], s59 offen
  s_add_u32 s59, s59, 32768
  buffer_load_dwordx4 v[220:223], v19, s[20:23], s59 offen
  s_add_u32 s59, s59, 32768
  buffer_load_dwordx4 v[224:227], v16, s[20:23], s59 offen
  s_add_u32 s59, s59, 32768
  buffer_load_dwordx4 v[228:231], v17, s[20:23], s59 offen
  s_add_u32 s59, s59, 32768
  buffer_load_dwordx4 v[232:235], v18, s[20:23], s59 offen
  s_add_u32 s59, s59, 32768
  buffer_load_dwordx4 v[236:239], v19, s[20:23], s59 offen
  s_add_u32 s59, s59, 32768
  buffer_load_dwordx4 v[240:243], v16, s[20:23], s59 offen
  s_add_u32 s59, s59, 32768
  buffer_load_dwordx4 v[244:247], v17, s[20:23], s59 offen
  s_add_u32 s59, s59, 32768
  buffer_load_dwordx4 v[248:251], v18, s[20:23], s59 offen
  s_add_u32 s59, s59, 32768
  buffer_load_dwordx4 v[252:255], v19, s[20:23], s59 offen
  s_add_u32 s59, s59, 32768
  s_waitcnt vmcnt(20)
  s_barrier
  v_xor_b32 v12, s3, v22
  v_lshl_add_u32 v12, v12, 5, v21
  v_add_u32 v13, 0xc000, v12
  v_add_u32 v20, 0x18000, v12
  v_add_u32 v23, 0x24000, v12
  ds_read_b64_tr_b16 v[96:97], v12 offset:0
  ds_read_b64_tr_b16 v[98:99], v12 offset:512
  ds_read_b64_tr_b16 v[100:101], v12 offset:8192
  ds_read_b64_tr_b16 v[102:103], v12 offset:8704
  ds_read_b64_tr_b16 v[104:105], v12 offset:16384
  ds_read_b64_tr_b16 v[106:107], v12 offset:16896
  ds_read_b64_tr_b16 v[108:109], v12 offset:24576
  ds_read_b64_tr_b16 v[110:111], v12 offset:25088
  s_waitcnt lgkmcnt(0)
  ds_read_b64_tr_b16 v[112:113], v12 offset:32768
  ds_read_b64_tr_b16 v[114:115], v12 offset:33280
  ds_read_b64_tr_b16 v[116:117], v12 offset:40960
  ds_read_b64_tr_b16 v[118:119], v12 offset:41472
  ds_read_b64_tr_b16 v[120:121], v13 offset:0
  ds_read_b64_tr_b16 v[122:123], v13 offset:512
  ds_read_b64_tr_b16 v[124:125], v13 offset:8192
  ds_read_b64_tr_b16 v[126:127], v13 offset:8704
  s_waitcnt lgkmcnt(0)
  ds_read_b64_tr_b16 v[128:129], v13 offset:16384
  ds_read_b64_tr_b16 v[130:131], v13 offset:16896
  ds_read_b64_tr_b16 v[132:133], v13 offset:24576
  ds_read_b64_tr_b16 v[134:135], v13 offset:25088
  ds_read_b64_tr_b16 v[136:137], v13 offset:32768
  ds_read_b64_tr_b16 v[138:139], v13 offset:33280
  ds_read_b64_tr_b16 v[140:141], v13 offset:40960
  ds_read_b64_tr_b16 v[142:143], v13 offset:41472
  s_waitcnt lgkmcnt(0)
  ds_read_b64_tr_b16 v[144:145], v20 offset:0
  ds_read_b64_tr_b16 v[146:147], v20 offset:512
  ds_read_b64_tr_b16 v[148:149], v20 offset:8192
  ds_read_b64_tr_b16 v[150:151], v20 offset:8704
  ds_read_b64_tr_b16 v[152:153], v20 offset:16384
  ds_read_b64_tr_b16 v[154:155], v20 offset:16896
  ds_read_b64_tr_b16 v[156:157], v20 offset:24576
  ds_read_b64_tr_b16 v[158:159], v20 offset:25088
  s_waitcnt lgkmcnt(0)
  ds_read_b64_tr_b16 v[160:161], v20 offset:32768
  ds_read_b64_tr_b16 v[162:163], v20 offset:33280
  ds_read_b64_tr_b16 v[164:165], v20 offset:40960
  ds_read_b64_tr_b16 v[166:167], v20 offset:41472
  ds_read_b64_tr_b16 v[168:169], v23 offset:0
  ds_read_b64_tr_b16 v[170:171], v23 offset:512
  ds_read_b64_tr_b16 v[172:173], v23 offset:8192
  ds_read_b64_tr_b16 v[174:175], v23 offset:8704
  s_waitcnt lgkmcnt(0)
  s_barrier
  s_mul_i32 s6, s3, 20480
  v_add_u32 v12, s6, v9
  s_waitcnt vmcnt(19)
  ds_write_b128 v12, v[176:179] offset:0
  s_waitcnt vmcnt(18)
  ds_write_b128 v12, v[180:183] offset:1024
  s_waitcnt vmcnt(17)
  ds_write_b128 v12, v[184:187] offset:2048
  s_waitcnt vmcnt(16)
  ds_write_b128 v12, v[188:191] offset:3072
  s_waitcnt vmcnt(15)
  ds_write_b128 v12, v[192:195] offset:4096
  s_waitcnt vmcnt(14)
  ds_write_b128 v12, v[196:199] offset:5120
  s_waitcnt vmcnt(13)
  ds_write_b128 v12, v[200:203] offset:6144
  s_waitcnt vmcnt(12)
  ds_write_b128 v12, v[204:207] offset:7168
  s_waitcnt vmcnt(11)
  ds_write_b128 v12, v[208:211] offset:8192
  s_waitcnt vmcnt(10)
  ds_write_b128 v12, v[212:215] offset:9216
  s_waitcnt vmcnt(9)
  ds_write_b128 v12, v[216:219] offset:10240
  s_waitcnt vmcnt(8)
  ds_write_b128 v12, v[220:223] offset:11264
  s_waitcnt vmcnt(7)
  ds_write_b128 v12, v[224:227] offset:12288
  s_waitcnt vmcnt(6)
  ds_write_b128 v12, v[228:231] offset:13312
  s_waitcnt vmcnt(5)
  ds_write_b128 v12, v[232:235] offset:14336
  s_waitcnt vmcnt(4)
  ds_write_b128 v12, v[236:239] offset:15360
  s_waitcnt vmcnt(3)
  ds_write_b128 v12, v[240:243] offset:16384
  s_waitcnt vmcnt(2)
  ds_write_b128 v12, v[244:247] offset:17408
  s_waitcnt vmcnt(1)
  ds_write_b128 v12, v[248:251] offset:18432
  s_waitcnt vmcnt(0)
  ds_write_b128 v12, v[252:255] offset:19456
  s_waitcnt lgkmcnt(0)
  s_barrier
  v_xor_b32 v12, s3, v22
  v_lshl_add_u32 v12, v12, 5, v21
  v_add_u32 v13, 0xc000, v12
  v_add_u32 v20, 0x18000, v12
  v_add_u32 v23, 0x24000, v12
  ds_read_b64_tr_b16 v[176:177], v12 offset:0
  ds_read_b64_tr_b16 v[178:179], v12 offset:512
  ds_read_b64_tr_b16 v[180:181], v12 offset:8192
  ds_read_b64_tr_b16 v[182:183], v12 offset:8704
  ds_read_b64_tr_b16 v[184:185], v12 offset:16384
  ds_read_b64_tr_b16 v[186:187], v12 offset:16896
  ds_read_b64_tr_b16 v[188:189], v12 offset:24576
  ds_read_b64_tr_b16 v[190:191], v12 offset:25088
  s_waitcnt lgkmcnt(0)
  ds_read_b64_tr_b16 v[192:193], v12 offset:32768
  ds_read_b64_tr_b16 v[194:195], v12 offset:33280
  ds_read_b64_tr_b16 v[196:197], v12 offset:40960
  ds_read_b64_tr_b16 v[198:199], v12 offset:41472
  ds_read_b64_tr_b16 v[200:201], v13 offset:0
  ds_read_b64_tr_b16 v[202:203], v13 offset:512
  ds_read_b64_tr_b16 v[204:205], v13 offset:8192
  ds_read_b64_tr_b16 v[206:207], v13 offset:8704
  s_waitcnt lgkmcnt(0)
  ds_read_b64_tr_b16 v[208:209], v13 offset:16384
  ds_read_b64_tr_b16 v[210:211], v13 offset:16896
  ds_read_b64_tr_b16 v[212:213], v13 offset:24576
  ds_read_b64_tr_b16 v[214:215], v13 offset:25088
  ds_read_b64_tr_b16 v[216:217], v13 offset:32768
  ds_read_b64_tr_b16 v[218:219], v13 offset:33280
  ds_read_b64_tr_b16 v[220:221], v13 offset:40960
  ds_read_b64_tr_b16 v[222:223], v13 offset:41472
  s_waitcnt lgkmcnt(0)
  ds_read_b64_tr_b16 v[224:225], v20 offset:0
  ds_read_b64_tr_b16 v[226:227], v20 offset:512
  ds_read_b64_tr_b16 v[228:229], v20 offset:8192
  ds_read_b64_tr_b16 v[230:231], v20 offset:8704
  ds_read_b64_tr_b16 v[232:233], v20 offset:16384
  ds_read_b64_tr_b16 v[234:235], v20 offset:16896
  ds_read_b64_tr_b16 v[236:237], v20 offset:24576
  ds_read_b64_tr_b16 v[238:239], v20 offset:25088
  s_waitcnt lgkmcnt(0)
  ds_read_b64_tr_b16 v[240:241], v20 offset:32768
  ds_read_b64_tr_b16 v[242:243], v20 offset:33280
  ds_read_b64_tr_b16 v[244:245], v20 offset:40960
  ds_read_b64_tr_b16 v[246:247], v20 offset:41472
  ds_read_b64_tr_b16 v[248:249], v23 offset:0
  ds_read_b64_tr_b16 v[250:251], v23 offset:512
  ds_read_b64_tr_b16 v[252:253], v23 offset:8192
  ds_read_b64_tr_b16 v[254:255], v23 offset:8704
  s_waitcnt lgkmcnt(0)
  v_mov_b32 v12, 0x4444
  v_mov_b32 v13, 0xeeee
  v_cndmask_b32 v4, v12, v13, s[62:63]
  s_mul_i32 s75, s3, 1280
  v_add_u32 v11, s75, v9
  v_lshlrev_b32 v0, 2, v1
  v_add_u32 v10, s75, v0
  v_lshrrev_b32 v12, 4, v1
  v_lshlrev_b32 v12, 3, v12
  v_bfe_u32 v13, v1, 2, 2
  v_add_u32 v12, v12, v13
  v_mul_u32_u24 v12, 40, v12
  v_and_b32 v13, 3, v1
  v_lshl_add_u32 v3, v13, 3, v12
  v_and_b32 v12, 15, v1
  v_mul_u32_u24 v12, 40, v12
  v_bfe_u32 v13, v1, 4, 1
  v_lshl_add_u32 v12, v13, 4, v12
  v_lshrrev_b32 v13, 5, v1
  v_lshl_add_u32 v2, v13, 3, v12
  v_lshrrev_b32 v12, 4, v1
  v_lshlrev_b32 v12, 7, v12
  v_bfe_u32 v13, v1, 2, 2
  v_lshl_add_u32 v12, v13, 5, v12
  v_and_b32 v13, 1, v1
  v_lshl_add_u32 v86, v13, 4, v12
  s_mul_i32 s6, s3, 640
  s_add_u32 s6, s6, 10240
  v_add_u32 v2, s6, v2
  v_add_u32 v3, 10240, v3
  v_lshlrev_b32 v12, 5, v1
  s_mov_b32 s59, 65536
L_rdy_1053:
  buffer_load_dword v13, v12, s[12:15], 0 offen offset:4 sc1
  s_waitcnt vmcnt(0)
  v_readlane_b32 s57, v13, 0
  v_readlane_b32 s58, v13, 1
  s_add_u32 s57, s57, s58
  v_readlane_b32 s58, v13, 2
  s_add_u32 s57, s57, s58
  v_readlane_b32 s58, v13, 3
  s_add_u32 s57, s57, s58
  v_readlane_b32 s58, v13, 4
  s_add_u32 s57, s57, s58
  v_readlane_b32 s58, v13, 5
  s_add_u32 s57, s57, s58
  v_readlane_b32 s58, v13, 6
  s_add_u32 s57, s57, s58
  v_readlane_b32 s58, v13, 7
  s_add_u32 s57, s57, s58
  s_cmp_ge_u32 s57, 256
  s_cbranch_scc1 L_rdyd_1054
  s_sleep 8
  s_sub_u32 s59, s59, 1
  s_cmp_lg_u32 s59, 0
  s_cbranch_scc1 L_rdy_1053
  s_endpgm
L_rdyd_1054:
  s_mov_b32 s6, 65536
  v_mov_b32 v15, 8
L_sd_1055:
  buffer_load_dwordx3 v[12:14], v15, s[12:15], 0 offen sc1
  s_waitcnt vmcnt(0)
  v_readfirstlane_b32 s73, v14
  s_cmp_ge_u32 s73, 0
  s_cbranch_scc1 L_se_1056
  s_sleep 8
  s_sub_u32 s6, s6, 1
  s_cmp_lg_u32 s6, 0
  s_cbranch_scc1 L_sd_1055
  s_endpgm
L_se_1056:
  v_readfirstlane_b32 s73, v12
  s_cmp_gt_i32 s73, 0
  s_cselect_b32 s73, 0x2000, 0
  v_readfirstlane_b32 s74, v13
  s_add_u32 s57, s49, 32
  v_and_b32 v95, 7, v1
  s_lshl_b32 s6, s57, 3
  v_add_u32 v95, s6, v95
  v_lshlrev_b32 v95, 2, v95
  v_add_u32 v95, 0x280000, v95
  v_subrev_u32 v12, 1024, v95
  v_cndmask_b32 v95, v95, v12, s[62:63]
  s_lshl_b32 s33, s57, 13
  s_lshl_b32 s6, s3, 10
  s_add_u32 s33, s33, s6
  s_add_u32 s33, s33, 0x400000
  s_add_u32 s6, s6, 16384
  v_add_u32 v6, s6, v9
  v_bfe_u32 v12, v1, 1, 1
  v_lshl_add_u32 v7, v12, 3, v86
  v_add_u32 v8, 32768, v9
  v_add_u32 v6, 16384, v6
  s_barrier
  s_setprio 1
  s_cmp_lt_u32 s3, 4
  s_cbranch_scc0 L_ap_1057
  s_setprio 3
L_ap_1057:
  s_cmp_lg_u32 s74, 0
  s_cbranch_scc1 L_qk_slow
  s_add_u32 s59, s48, 0
  s_min_u32 s59, s59, 63
  s_lshr_b32 s59, s59, 1
  s_cmp_gt_u32 s72, s59
  s_cbranch_scc0 L_q0_poll
L_q0_go:
  buffer_load_dwordx4 v[76:79], v9, s[8:11], s33 offen sc1
  s_sub_u32 s6, s33, 262144
  buffer_load_dwordx4 v[80:83], v9, s[8:11], s6 offen sc1
  s_add_u32 s33, s33, 786432
  s_branch L_qk_k
L_qk_top:
  v_mov_b32 v56, 0
  v_mov_b32 v57, 0
  v_mov_b32 v58, 0
  v_mov_b32 v59, 0
  v_mov_b32 v60, 0
  v_mov_b32 v61, 0
  v_mov_b32 v62, 0
  v_mov_b32 v63, 0
  s_sleep 6
  s_nop 7
L_qk_first:
  buffer_load_dwordx4 v[72:75], v9, s[8:11], s50 offen sc1
  buffer_load_dword v76, v0, s[8:11], s50 offen offset:1024 sc1
  s_nop 15
  s_nop 11
L_qm_l:
  buffer_load_dwordx4 v[78:81], v9, s[8:11], s50 offen sc1
  buffer_load_dword v82, v0, s[8:11], s50 offen offset:1024 sc1
  s_waitcnt vmcnt(2)
  v_max3_u32 v14, v72, v73, v74
  v_max3_u32 v14, v14, v75, v76
  v_cmp_eq_u32 vcc, -1, v14
  s_cbranch_vccnz L_qm_t
  ds_write_b128 v11, v[72:75]
  ds_write_b32 v10, v76 offset:1024
L_qm_o:
  s_waitcnt lgkmcnt(0)
  s_barrier
  s_cmp_eq_u32 s3, 0
  s_cbranch_scc1 L_qk_w0
  ds_read_b128 v[16:19], v9 offset:0
  ds_read_b128 v[20:23], v9 offset:1024
  ds_read_b128 v[24:27], v9 offset:2048
  ds_read_b128 v[28:31], v9 offset:3072
  ds_read_b128 v[32:35], v9 offset:4096
  ds_read_b128 v[36:39], v9 offset:5120
  ds_read_b128 v[40:43], v9 offset:6144
  ds_read_b128 v[44:47], v9 offset:7168
  ds_read_b128 v[48:51], v9 offset:8192
  ds_read_b128 v[52:55], v9 offset:9216
  s_waitcnt lgkmcnt(9)
  v_smfmac_f32_16x16x64_bf16 v[56:59], v[16:19], v[96:103], v4
  v_smfmac_f32_16x16x64_bf16 v[60:63], v[16:19], v[176:183], v4
  s_waitcnt lgkmcnt(8)
  v_smfmac_f32_16x16x64_bf16 v[56:59], v[20:23], v[104:111], v4
  v_smfmac_f32_16x16x64_bf16 v[60:63], v[20:23], v[184:191], v4
  s_waitcnt lgkmcnt(7)
  v_smfmac_f32_16x16x64_bf16 v[56:59], v[24:27], v[112:119], v4
  v_smfmac_f32_16x16x64_bf16 v[60:63], v[24:27], v[192:199], v4
  s_waitcnt lgkmcnt(6)
  v_smfmac_f32_16x16x64_bf16 v[56:59], v[28:31], v[120:127], v4
  v_smfmac_f32_16x16x64_bf16 v[60:63], v[28:31], v[200:207], v4
  s_waitcnt lgkmcnt(5)
  v_smfmac_f32_16x16x64_bf16 v[56:59], v[32:35], v[128:135], v4
  v_smfmac_f32_16x16x64_bf16 v[60:63], v[32:35], v[208:215], v4
  s_waitcnt lgkmcnt(4)
  v_smfmac_f32_16x16x64_bf16 v[56:59], v[36:39], v[136:143], v4
  v_smfmac_f32_16x16x64_bf16 v[60:63], v[36:39], v[216:223], v4
  s_waitcnt lgkmcnt(3)
  v_smfmac_f32_16x16x64_bf16 v[56:59], v[40:43], v[144:151], v4
  v_smfmac_f32_16x16x64_bf16 v[60:63], v[40:43], v[224:231], v4
  s_waitcnt lgkmcnt(2)
  v_smfmac_f32_16x16x64_bf16 v[56:59], v[44:47], v[152:159], v4
  v_smfmac_f32_16x16x64_bf16 v[60:63], v[44:47], v[232:239], v4
  s_waitcnt lgkmcnt(1)
  v_smfmac_f32_16x16x64_bf16 v[56:59], v[48:51], v[160:167], v4
  v_smfmac_f32_16x16x64_bf16 v[60:63], v[48:51], v[240:247], v4
  s_waitcnt lgkmcnt(0)
  v_smfmac_f32_16x16x64_bf16 v[56:59], v[52:55], v[168:175], v4
  v_smfmac_f32_16x16x64_bf16 v[60:63], v[52:55], v[248:255], v4
  s_nop 6
  v_permlane32_swap_b32 v56, v58
  v_permlane32_swap_b32 v57, v59
  v_permlane32_swap_b32 v60, v62
  v_permlane32_swap_b32 v61, v63
  v_pk_add_f32 v[56:57], v[56:57], v[58:59]
  v_pk_add_f32 v[60:61], v[60:61], v[62:63]
  v_cvt_pk_bf16_f32 v56, v56, v57
  v_cvt_pk_bf16_f32 v57, v60, v61
  ds_write_b64 v2, v[56:57]
  s_waitcnt vmcnt(0) lgkmcnt(0)
  s_barrier
  s_cmp_lt_u32 s3, 3
  s_cbranch_scc1 L_qk_tok
  s_barrier
  s_add_u32 s59, s48, 1
  s_min_u32 s59, s59, 63
  s_lshr_b32 s59, s59, 1
  s_cmp_gt_u32 s72, s59
  s_cbranch_scc0 L_q1_poll
L_q1_go:
  buffer_load_dwordx4 v[76:79], v9, s[8:11], s33 offen sc1
  s_sub_u32 s6, s33, 262144
  buffer_load_dwordx4 v[80:83], v9, s[8:11], s6 offen sc1
  s_add_u32 s33, s33, 786432
  s_cmp_eq_u32 s3, 5
  s_cbranch_scc0 L_qk_nx
  s_add_u32 s34, s48, 3
  s_and_b32 s34, s34, 3
  s_lshl_b32 s34, s34, 18
  s_add_u32 s34, s34, s79
  s_lshl_b32 s7, s47, 9
  s_add_u32 s7, s7, s34
  s_add_u32 s7, s7, 0x2000
  s_lshl_b32 s6, s47, 2
  s_add_u32 s6, s6, s34
  s_add_u32 s6, s6, 0x2800
  s_mov_b64 exec, s[60:61]
  buffer_store_dwordx4 v[88:91], v5, s[8:11], s7 offen
  buffer_store_dword v88, v5, s[8:11], s6 offen
  s_mov_b64 exec, -1
  s_add_u32 s34, s48, 2
  s_and_b32 s34, s34, 3
  s_lshl_b32 s34, s34, 18
  s_add_u32 s34, s34, s79
  s_lshl_b32 s37, s47, 11
  s_add_u32 s37, s37, s34
  s_add_u32 s37, s37, 0x4000
  s_lshl_b32 s38, s47, 2
  s_add_u32 s38, s38, s34
  s_add_u32 s38, s38, 0x6000
  buffer_store_dwordx4 v[88:91], v9, s[8:11], s37 offen offset:0
  buffer_store_dwordx4 v[88:91], v9, s[8:11], s37 offen offset:1024
  buffer_store_dword v88, v9, s[8:11], s38 offen offset:0
  buffer_store_dword v88, v9, s[8:11], s38 offen offset:1024
  s_branch L_qk_nx
L_qk_tok:
  s_nop 15
  s_nop 15
  s_sub_u32 s59, s3, 1
  s_lshl_b32 s6, s59, 10
  v_add_u32 v12, s6, v8
  ds_read_b128 v[16:19], v8 offset:0
  ds_read_b128 v[48:51], v12 offset:8192
  ds_read_b128 v[20:23], v8 offset:2048
  ds_read_b128 v[52:55], v12 offset:10240
  ds_read_b128 v[24:27], v8 offset:4096
  ds_read_b128 v[56:59], v12 offset:12288
  ds_read_b128 v[28:31], v8 offset:6144
  ds_read_b128 v[60:63], v12 offset:14336
  ds_read_b128 v[32:35], v8 offset:1024
  ds_read_b128 v[36:39], v8 offset:3072
  ds_read_b128 v[40:43], v8 offset:5120
  ds_read_b128 v[44:47], v8 offset:7168
  s_waitcnt lgkmcnt(4)
  v_mfma_f32_16x16x32_bf16 v[64:67], v[16:19], v[48:51], 0
  v_mfma_f32_16x16x32_bf16 v[64:67], v[20:23], v[52:55], v[64:67]
  v_mfma_f32_16x16x32_bf16 v[64:67], v[24:27], v[56:59], v[64:67]
  v_mfma_f32_16x16x32_bf16 v[64:67], v[28:31], v[60:63], v[64:67]
  s_waitcnt lgkmcnt(0)
  v_mfma_f32_16x16x32_bf16 v[68:71], v[32:35], v[48:51], 0
  v_mfma_f32_16x16x32_bf16 v[68:71], v[36:39], v[52:55], v[68:71]
  v_mfma_f32_16x16x32_bf16 v[68:71], v[40:43], v[56:59], v[68:71]
  v_mfma_f32_16x16x32_bf16 v[68:71], v[44:47], v[60:63], v[68:71]
  ds_read_b64_tr_b16 v[16:17], v3 offset:0
  ds_read_b64_tr_b16 v[18:19], v3 offset:160
  ds_read_b64_tr_b16 v[20:21], v3 offset:1280
  ds_read_b64_tr_b16 v[22:23], v3 offset:1440
  ds_read_b64_tr_b16 v[24:25], v3 offset:2560
  ds_read_b64_tr_b16 v[26:27], v3 offset:2720
  ds_read_b64_tr_b16 v[28:29], v3 offset:3840
  ds_read_b64_tr_b16 v[30:31], v3 offset:4000
  v_and_b32 v12, 15, v1
  v_lshrrev_b32 v13, 4, v1
  v_lshlrev_b32 v13, 2, v13
  v_sub_u32 v12, v12, v13
  s_mul_i32 s6, s59, 99
  v_add_u32 v13, s6, v12
  v_subrev_u32 v12, 99, v13
  s_waitcnt lgkmcnt(0)
  v_mfma_f32_16x16x32_bf16 v[72:75], v[16:19], v[48:51], 0
  v_mfma_f32_16x16x32_bf16 v[72:75], v[20:23], v[52:55], v[72:75]
  v_mfma_f32_16x16x32_bf16 v[72:75], v[24:27], v[56:59], v[72:75]
  v_mfma_f32_16x16x32_bf16 v[72:75], v[28:31], v[60:63], v[72:75]
  s_barrier
  s_add_u32 s59, s48, 1
  s_min_u32 s59, s59, 63
  s_lshr_b32 s59, s59, 1
  s_cmp_gt_u32 s72, s59
  s_cbranch_scc0 L_q3_poll
L_q3_go:
  buffer_load_dwordx4 v[76:79], v9, s[8:11], s33 offen sc1
  s_sub_u32 s6, s33, 262144
  buffer_load_dwordx4 v[80:83], v9, s[8:11], s6 offen sc1
  s_add_u32 s33, s33, 786432
  v_mov_b32 v32, 0xff800000
  v_cmp_le_i32 vcc, 0, v13
  s_nop 1
  v_cndmask_b32 v64, v32, v64, vcc
  v_cmp_le_i32 vcc, 1, v13
  s_nop 1
  v_cndmask_b32 v65, v32, v65, vcc
  v_cmp_le_i32 vcc, 2, v13
  s_nop 1
  v_cndmask_b32 v66, v32, v66, vcc
  v_cmp_le_i32 vcc, 3, v13
  s_nop 1
  v_cndmask_b32 v67, v32, v67, vcc
  v_cmp_le_i32 vcc, 0, v12
  s_nop 1
  v_cndmask_b32 v68, v32, v68, vcc
  v_cmp_le_i32 vcc, 1, v12
  s_nop 1
  v_cndmask_b32 v69, v32, v69, vcc
  v_cmp_le_i32 vcc, 2, v12
  s_nop 1
  v_cndmask_b32 v70, v32, v70, vcc
  v_cmp_le_i32 vcc, 3, v12
  s_nop 1
  v_cndmask_b32 v71, v32, v71, vcc
  v_mov_b32 v72, v74
  v_mov_b32 v73, v75
  v_max3_f32 v34, v64, v65, v66
  v_max3_f32 v34, v34, v67, v68
  v_max3_f32 v34, v34, v69, v70
  v_max3_f32 v34, v34, v71, v72
  v_max_f32 v34, v34, v73
  v_mov_b32 v35, v34
  s_nop 1
  v_permlane32_swap_b32 v34, v35
  v_max_f32 v34, v34, v35
  v_mov_b32 v35, v34
  s_nop 1
  v_permlane16_swap_b32 v34, v35
  v_max_f32 v34, v34, v35
  v_mul_f32 v34, s70, v34
  v_fma_f32 v64, v64, s70, -v34
  v_fma_f32 v65, v65, s70, -v34
  v_fma_f32 v66, v66, s70, -v34
  v_fma_f32 v67, v67, s70, -v34
  v_fma_f32 v68, v68, s70, -v34
  v_fma_f32 v69, v69, s70, -v34
  v_fma_f32 v70, v70, s70, -v34
  v_fma_f32 v71, v71, s70, -v34
  v_fma_f32 v72, v72, s70, -v34
  v_fma_f32 v73, v73, s70, -v34
  v_exp_f32 v64, v64
  v_exp_f32 v65, v65
  v_exp_f32 v66, v66
  v_exp_f32 v67, v67
  v_exp_f32 v68, v68
  v_exp_f32 v69, v69
  v_exp_f32 v70, v70
  v_exp_f32 v71, v71
  v_exp_f32 v72, v72
  v_exp_f32 v73, v73
  v_pk_add_f32 v[34:35], v[64:65], v[66:67]
  v_pk_add_f32 v[34:35], v[34:35], v[68:69]
  v_pk_add_f32 v[34:35], v[34:35], v[70:71]
  v_pk_add_f32 v[34:35], v[34:35], v[72:73]
  v_add_f32 v34, v34, v35
  v_mov_b32 v35, v34
  s_nop 1
  v_permlane32_swap_b32 v34, v35
  v_add_f32 v34, v34, v35
  v_mov_b32 v35, v34
  s_nop 1
  v_permlane16_swap_b32 v34, v35
  v_add_f32 v34, v34, v35
  v_rcp_f32 v34, v34
  s_nop 0
  v_pk_mul_f32 v[64:65], v[64:65], v[34:35] op_sel_hi:[1,0]
  v_pk_mul_f32 v[66:67], v[66:67], v[34:35] op_sel_hi:[1,0]
  v_pk_mul_f32 v[68:69], v[68:69], v[34:35] op_sel_hi:[1,0]
  v_pk_mul_f32 v[70:71], v[70:71], v[34:35] op_sel_hi:[1,0]
  v_pk_mul_f32 v[72:73], v[72:73], v[34:35] op_sel_hi:[1,0]
  v_cvt_pk_bf16_f32 v64, v64, v65
  v_cvt_pk_bf16_f32 v65, v66, v67
  v_cvt_pk_bf16_f32 v66, v68, v69
  v_cvt_pk_bf16_f32 v67, v70, v71
  v_cvt_pk_bf16_f32 v68, v72, v73
  v_min_u32 v67, -2, v67
  v_min_u32 v68, -2, v68
  s_lshl_b32 s37, s47, 11
  s_add_u32 s37, s37, s51
  s_add_u32 s37, s37, 0x4000
  s_lshl_b32 s38, s47, 2
  s_add_u32 s38, s38, s51
  s_add_u32 s38, s38, 0x6000
  s_sub_u32 s6, s3, 1
  s_lshl_b32 s6, s6, 10
  s_add_u32 s37, s37, s6
  s_add_u32 s38, s38, s6
  buffer_store_dwordx4 v[64:67], v9, s[8:11], s37 offen
  buffer_store_dword v68, v9, s[8:11], s38 offen
  s_branch L_qk_nx
L_qk_w0:
  ds_read_b128 v[16:19], v9 offset:0
  ds_read_b128 v[20:23], v9 offset:1024
  ds_read_b128 v[24:27], v9 offset:2048
  ds_read_b128 v[28:31], v9 offset:3072
  ds_read_b128 v[32:35], v9 offset:4096
  ds_read_b128 v[36:39], v9 offset:5120
  ds_read_b128 v[40:43], v9 offset:6144
  ds_read_b128 v[44:47], v9 offset:7168
  ds_read_b128 v[48:51], v9 offset:8192
  ds_read_b128 v[52:55], v9 offset:9216
  s_waitcnt lgkmcnt(9)
  v_smfmac_f32_16x16x64_bf16 v[56:59], v[16:19], v[96:103], v4
  v_smfmac_f32_16x16x64_bf16 v[60:63], v[16:19], v[176:183], v4
  s_waitcnt lgkmcnt(8)
  v_smfmac_f32_16x16x64_bf16 v[56:59], v[20:23], v[104:111], v4
  v_smfmac_f32_16x16x64_bf16 v[60:63], v[20:23], v[184:191], v4
  s_waitcnt lgkmcnt(7)
  v_smfmac_f32_16x16x64_bf16 v[56:59], v[24:27], v[112:119], v4
  v_smfmac_f32_16x16x64_bf16 v[60:63], v[24:27], v[192:199], v4
  s_waitcnt lgkmcnt(6)
  v_smfmac_f32_16x16x64_bf16 v[56:59], v[28:31], v[120:127], v4
  v_smfmac_f32_16x16x64_bf16 v[60:63], v[28:31], v[200:207], v4
  s_waitcnt lgkmcnt(5)
  v_smfmac_f32_16x16x64_bf16 v[56:59], v[32:35], v[128:135], v4
  v_smfmac_f32_16x16x64_bf16 v[60:63], v[32:35], v[208:215], v4
  s_waitcnt lgkmcnt(4)
  v_smfmac_f32_16x16x64_bf16 v[56:59], v[36:39], v[136:143], v4
  v_smfmac_f32_16x16x64_bf16 v[60:63], v[36:39], v[216:223], v4
  s_waitcnt lgkmcnt(3)
  v_smfmac_f32_16x16x64_bf16 v[56:59], v[40:43], v[144:151], v4
  v_smfmac_f32_16x16x64_bf16 v[60:63], v[40:43], v[224:231], v4
  s_waitcnt lgkmcnt(2)
  v_smfmac_f32_16x16x64_bf16 v[56:59], v[44:47], v[152:159], v4
  v_smfmac_f32_16x16x64_bf16 v[60:63], v[44:47], v[232:239], v4
  s_waitcnt lgkmcnt(1)
  v_smfmac_f32_16x16x64_bf16 v[56:59], v[48:51], v[160:167], v4
  v_smfmac_f32_16x16x64_bf16 v[60:63], v[48:51], v[240:247], v4
  s_waitcnt lgkmcnt(0)
  v_smfmac_f32_16x16x64_bf16 v[56:59], v[52:55], v[168:175], v4
  v_smfmac_f32_16x16x64_bf16 v[60:63], v[52:55], v[248:255], v4
  s_nop 6
  v_permlane32_swap_b32 v56, v58
  v_permlane32_swap_b32 v57, v59
  v_permlane32_swap_b32 v60, v62
  v_permlane32_swap_b32 v61, v63
  v_pk_add_f32 v[56:57], v[56:57], v[58:59]
  v_pk_add_f32 v[60:61], v[60:61], v[62:63]
  v_cvt_pk_bf16_f32 v56, v56, v57
  v_cvt_pk_bf16_f32 v57, v60, v61
  ds_write_b64 v2, v[56:57]
  ds_read_b128 v[16:19], v8 offset:0
  ds_read_b128 v[20:23], v8 offset:1024
  ds_read_b128 v[24:27], v8 offset:2048
  ds_read_b128 v[28:31], v8 offset:3072
  ds_read_b128 v[32:35], v8 offset:4096
  ds_read_b128 v[36:39], v8 offset:5120
  ds_read_b128 v[40:43], v8 offset:6144
  ds_read_b128 v[44:47], v8 offset:7168
  s_lshl_b32 s53, s47, 9
  s_add_u32 s53, s53, s51
  s_add_u32 s53, s53, 0x2000
  s_lshl_b32 s54, s47, 2
  s_add_u32 s54, s54, s51
  s_add_u32 s54, s54, 0x2800
  s_mov_b64 vcc, s[64:65]
  s_cmp_eq_u32 s48, 63
  s_waitcnt lgkmcnt(8)
  s_barrier
  ds_read_b64_tr_b16 v[48:49], v3 offset:0
  ds_read_b64_tr_b16 v[50:51], v3 offset:160
  ds_read_b64_tr_b16 v[52:53], v3 offset:1280
  ds_read_b64_tr_b16 v[54:55], v3 offset:1440
  ds_read_b64_tr_b16 v[56:57], v3 offset:2560
  ds_read_b64_tr_b16 v[58:59], v3 offset:2720
  ds_read_b64_tr_b16 v[60:61], v3 offset:3840
  ds_read_b64_tr_b16 v[62:63], v3 offset:4000
  s_cbranch_scc1 L_qk_bp
  s_waitcnt vmcnt(0)
  s_waitcnt lgkmcnt(6)
  v_mfma_f32_16x16x32_bf16 v[72:75], v[16:19], v[48:51], 0
  v_mfma_f32_16x16x32_bf16 v[76:79], v[20:23], v[48:51], 0
  v_mfma_f32_16x16x32_bf16 v[80:83], v[48:51], v[48:51], 0
  s_waitcnt lgkmcnt(4)
  v_mfma_f32_16x16x32_bf16 v[72:75], v[24:27], v[52:55], v[72:75]
  v_mfma_f32_16x16x32_bf16 v[76:79], v[28:31], v[52:55], v[76:79]
  v_mfma_f32_16x16x32_bf16 v[80:83], v[52:55], v[52:55], v[80:83]
  s_waitcnt lgkmcnt(2)
  v_mfma_f32_16x16x32_bf16 v[72:75], v[32:35], v[56:59], v[72:75]
  v_mfma_f32_16x16x32_bf16 v[76:79], v[36:39], v[56:59], v[76:79]
  v_mfma_f32_16x16x32_bf16 v[80:83], v[56:59], v[56:59], v[80:83]
  s_waitcnt lgkmcnt(0)
  v_mfma_f32_16x16x32_bf16 v[72:75], v[40:43], v[60:63], v[72:75]
  v_mfma_f32_16x16x32_bf16 v[76:79], v[44:47], v[60:63], v[76:79]
  v_mfma_f32_16x16x32_bf16 v[80:83], v[60:63], v[60:63], v[80:83]
  s_nop 6
  v_cndmask_b32 v72, v76, v72, vcc quad_perm:[0,1,0,1] row_mask:0xf bank_mask:0xf
  v_cndmask_b32 v73, v77, v73, vcc quad_perm:[0,1,0,1] row_mask:0xf bank_mask:0xf
  v_cndmask_b32 v74, v78, v74, vcc quad_perm:[0,1,0,1] row_mask:0xf bank_mask:0xf
  v_cndmask_b32 v75, v79, v75, vcc quad_perm:[0,1,0,1] row_mask:0xf bank_mask:0xf
  v_cndmask_b32 v76, v83, v82, vcc quad_perm:[0,1,0,1] row_mask:0xf bank_mask:0xf
  v_max3_f32 v16, v72, v73, v74
  v_max3_f32 v16, v16, v75, v76
  v_mul_f32 v18, s70, v16
  v_fma_f32 v72, v72, s70, -v18
  v_max_f32 v16, v16, v16 quad_perm:[2,3,0,1] row_mask:0xf bank_mask:0xf
  v_fma_f32 v73, v73, s70, -v18
  v_mov_b32 v17, v16
  v_fma_f32 v74, v74, s70, -v18
  v_fma_f32 v75, v75, s70, -v18
  v_permlane32_swap_b32 v16, v17
  v_fma_f32 v76, v76, s70, -v18
  v_max_f32 v16, v16, v17
  v_exp_f32 v72, v72
  v_mov_b32 v17, v16
  v_exp_f32 v73, v73
  v_exp_f32 v74, v74
  v_permlane16_swap_b32 v16, v17
  v_exp_f32 v75, v75
  v_max_f32 v16, v16, v17
  v_exp_f32 v76, v76
  v_fma_f32 v20, -v16, s70, v18
  v_exp_f32 v20, v20
  v_pk_add_f32 v[78:79], v[72:73], v[74:75]
  v_add_f32 v16, v76, v78
  v_mul_f32 v76, v76, v20
  v_add_f32 v16, v16, v79
  v_mul_f32 v16, v16, v20
  v_mov_b32 v77, v76 quad_perm:[2,3,0,1] row_mask:0xf bank_mask:0xf
  s_nop 0
  v_add_f32 v16, v16, v16 quad_perm:[2,3,0,1] row_mask:0xf bank_mask:0xf
  v_mov_b32 v17, v16
  s_nop 1
  v_permlane32_swap_b32 v16, v17
  v_add_f32 v16, v16, v17
  v_mov_b32 v17, v16
  s_nop 1
  v_permlane16_swap_b32 v16, v17
  v_add_f32 v16, v16, v17
  v_rcp_f32 v16, v16
  s_nop 0
  v_mul_f32 v20, v20, v16
  v_pk_mul_f32 v[76:77], v[76:77], v[16:17] op_sel_hi:[1,0]
  v_pk_mul_f32 v[72:73], v[72:73], v[20:21] op_sel_hi:[1,0]
  v_pk_mul_f32 v[74:75], v[74:75], v[20:21] op_sel_hi:[1,0]
  v_cvt_pk_bf16_f32 v78, v72, v73
  v_cvt_pk_bf16_f32 v79, v74, v75
  v_cvt_pk_bf16_f32 v80, v76, v77
  v_min_u32 v79, -2, v79
  v_min_u32 v80, -2, v80
  buffer_store_dwordx2 v[78:79], v7, s[8:11], s53 offen
  s_mov_b64 exec, s[64:65]
  buffer_store_dword v80, v86, s[8:11], s54 offen
  s_mov_b64 exec, -1
L_qk_bp:
  s_barrier
  s_add_u32 s59, s48, 1
  s_min_u32 s59, s59, 63
  s_lshr_b32 s59, s59, 1
  s_cmp_gt_u32 s72, s59
  s_cbranch_scc0 L_q2_poll
L_q2_go:
  buffer_load_dwordx4 v[76:79], v9, s[8:11], s33 offen sc1
  s_sub_u32 s6, s33, 262144
  buffer_load_dwordx4 v[80:83], v9, s[8:11], s6 offen sc1
  s_add_u32 s33, s33, 786432
L_qk_nx:
  s_cmp_eq_u32 s48, 63
  s_cbranch_scc1 L_qk_last
  s_add_u32 s48, s48, 1
L_qk_k:
  s_and_b32 s57, s48, 3
  s_lshl_b32 s50, s57, 16
  s_lshl_b32 s51, s57, 18
  s_add_u32 s50, s50, s78
  s_add_u32 s51, s51, s79
  s_add_u32 s50, s50, s75
  s_mov_b32 s56, 524288
  v_xor_b32 v8, 0xc000, v8
  v_xor_b32 v6, 0xc000, v6
  s_waitcnt vmcnt(0)
  ds_write_b128 v6, v[76:79]
  ds_write_b128 v6, v[80:83] offset:8192
  s_waitcnt lgkmcnt(0)
  s_barrier
  s_cmp_eq_u32 s3, 6
  s_cbranch_scc0 L_qk_nf
L_qk_nf:
  s_cmp_eq_u32 s48, 0
  s_cbranch_scc0 L_qk_top
  v_mov_b32 v56, 0
  v_mov_b32 v57, 0
  v_mov_b32 v58, 0
  v_mov_b32 v59, 0
  v_mov_b32 v60, 0
  v_mov_b32 v61, 0
  v_mov_b32 v62, 0
  v_mov_b32 v63, 0
  s_branch L_qk_first
L_qk_last:
  s_cmp_eq_u32 s3, 6
  s_cbranch_scc0 L_END
  s_endpgm
L_qm_t:
  buffer_load_dwordx4 v[72:75], v9, s[8:11], s50 offen sc1
  buffer_load_dword v76, v0, s[8:11], s50 offen offset:1024 sc1
  s_waitcnt vmcnt(2)
  v_max3_u32 v14, v78, v79, v80
  v_max3_u32 v14, v14, v81, v82
  v_cmp_eq_u32 vcc, -1, v14
  s_cbranch_vccz L_qm_b
  s_sub_u32 s56, s56, 1
  s_cmp_lg_u32 s56, 0
  s_cbranch_scc1 L_qm_l
  s_endpgm
L_qm_b:
  ds_write_b128 v11, v[78:81]
  ds_write_b32 v10, v82 offset:1024
  s_branch L_qm_o
L_q0_poll:
  buffer_load_dword v14, v95, s[8:11], 0 offen sc1
  s_waitcnt vmcnt(0)
  v_min_u32 v14, v14, v14 row_ror:8 row_mask:0xf bank_mask:0xf
  s_nop 1
  v_min_u32 v14, v14, v14 row_ror:4 row_mask:0xf bank_mask:0xf
  s_nop 1
  v_min_u32 v14, v14, v14 row_ror:2 row_mask:0xf bank_mask:0xf
  s_nop 1
  v_min_u32 v14, v14, v14 row_ror:1 row_mask:0xf bank_mask:0xf
  s_nop 0
  v_readfirstlane_b32 s72, v14
  s_cmp_gt_u32 s72, s59
  s_cbranch_scc1 L_q0_go
  s_sleep 2
  s_sub_u32 s56, s56, 1
  s_cmp_lg_u32 s56, 0
  s_cbranch_scc1 L_q0_poll
  s_endpgm
L_q1_poll:
  buffer_load_dword v14, v95, s[8:11], 0 offen sc1
  s_waitcnt vmcnt(0)
  v_min_u32 v14, v14, v14 row_ror:8 row_mask:0xf bank_mask:0xf
  s_nop 1
  v_min_u32 v14, v14, v14 row_ror:4 row_mask:0xf bank_mask:0xf
  s_nop 1
  v_min_u32 v14, v14, v14 row_ror:2 row_mask:0xf bank_mask:0xf
  s_nop 1
  v_min_u32 v14, v14, v14 row_ror:1 row_mask:0xf bank_mask:0xf
  s_nop 0
  v_readfirstlane_b32 s72, v14
  s_cmp_gt_u32 s72, s59
  s_cbranch_scc1 L_q1_go
  s_sleep 2
  s_sub_u32 s56, s56, 1
  s_cmp_lg_u32 s56, 0
  s_cbranch_scc1 L_q1_poll
  s_endpgm
L_q3_poll:
  buffer_load_dword v14, v95, s[8:11], 0 offen sc1
  s_waitcnt vmcnt(0)
  v_min_u32 v14, v14, v14 row_ror:8 row_mask:0xf bank_mask:0xf
  s_nop 1
  v_min_u32 v14, v14, v14 row_ror:4 row_mask:0xf bank_mask:0xf
  s_nop 1
  v_min_u32 v14, v14, v14 row_ror:2 row_mask:0xf bank_mask:0xf
  s_nop 1
  v_min_u32 v14, v14, v14 row_ror:1 row_mask:0xf bank_mask:0xf
  s_nop 0
  v_readfirstlane_b32 s72, v14
  s_cmp_gt_u32 s72, s59
  s_cbranch_scc1 L_q3_go
  s_sleep 2
  s_sub_u32 s56, s56, 1
  s_cmp_lg_u32 s56, 0
  s_cbranch_scc1 L_q3_poll
  s_endpgm
L_q2_poll:
  buffer_load_dword v14, v95, s[8:11], 0 offen sc1
  s_waitcnt vmcnt(0)
  v_min_u32 v14, v14, v14 row_ror:8 row_mask:0xf bank_mask:0xf
  s_nop 1
  v_min_u32 v14, v14, v14 row_ror:4 row_mask:0xf bank_mask:0xf
  s_nop 1
  v_min_u32 v14, v14, v14 row_ror:2 row_mask:0xf bank_mask:0xf
  s_nop 1
  v_min_u32 v14, v14, v14 row_ror:1 row_mask:0xf bank_mask:0xf
  s_nop 0
  v_readfirstlane_b32 s72, v14
  s_cmp_gt_u32 s72, s59
  s_cbranch_scc1 L_q2_go
  s_sleep 2
  s_sub_u32 s56, s56, 1
  s_cmp_lg_u32 s56, 0
  s_cbranch_scc1 L_q2_poll
  s_endpgm
L_qk_slow:
  s_add_u32 s59, s48, 0
  s_min_u32 s59, s59, 63
  s_lshr_b32 s59, s59, 1
  s_cmp_gt_u32 s72, s59
  s_cbranch_scc0 L_q0_poll_S
L_q0_go_S:
  buffer_load_dwordx4 v[76:79], v9, s[8:11], s33 offen sc1
  s_sub_u32 s6, s33, 262144
  buffer_load_dwordx4 v[80:83], v9, s[8:11], s6 offen sc1
  s_add_u32 s33, s33, 786432
  s_branch L_qk_k_S
L_qk_top_S:
  v_mov_b32 v56, 0
  v_mov_b32 v57, 0
  v_mov_b32 v58, 0
  v_mov_b32 v59, 0
  v_mov_b32 v60, 0
  v_mov_b32 v61, 0
  v_mov_b32 v62, 0
  v_mov_b32 v63, 0
  s_sleep 6
  s_nop 7
L_qk_first_S:
  buffer_load_dwordx4 v[72:75], v9, s[8:11], s50 offen sc1
  buffer_load_dword v76, v0, s[8:11], s50 offen offset:1024 sc1
  s_nop 15
  s_nop 11
L_qm_l_S:
  buffer_load_dwordx4 v[78:81], v9, s[8:11], s50 offen sc1
  buffer_load_dword v82, v0, s[8:11], s50 offen offset:1024 sc1
  s_waitcnt vmcnt(2)
  v_max3_u32 v14, v72, v73, v74
  v_max3_u32 v14, v14, v75, v76
  v_cmp_eq_u32 vcc, -1, v14
  s_cbranch_vccnz L_qm_t_S
  ds_write_b128 v11, v[72:75]
  ds_write_b32 v10, v76 offset:1024
L_qm_o_S:
  s_waitcnt lgkmcnt(0)
  s_barrier
  s_cmp_eq_u32 s3, 0
  s_cbranch_scc1 L_qk_w0_S
  ds_read_b128 v[16:19], v9 offset:0
  ds_read_b128 v[20:23], v9 offset:1024
  ds_read_b128 v[24:27], v9 offset:2048
  ds_read_b128 v[28:31], v9 offset:3072
  ds_read_b128 v[32:35], v9 offset:4096
  ds_read_b128 v[36:39], v9 offset:5120
  ds_read_b128 v[40:43], v9 offset:6144
  ds_read_b128 v[44:47], v9 offset:7168
  ds_read_b128 v[48:51], v9 offset:8192
  ds_read_b128 v[52:55], v9 offset:9216
  s_waitcnt lgkmcnt(9)
  v_smfmac_f32_16x16x64_bf16 v[56:59], v[16:19], v[96:103], v4
  v_smfmac_f32_16x16x64_bf16 v[60:63], v[16:19], v[176:183], v4
  s_waitcnt lgkmcnt(8)
  v_smfmac_f32_16x16x64_bf16 v[56:59], v[20:23], v[104:111], v4
  v_smfmac_f32_16x16x64_bf16 v[60:63], v[20:23], v[184:191], v4
  s_waitcnt lgkmcnt(7)
  v_smfmac_f32_16x16x64_bf16 v[56:59], v[24:27], v[112:119], v4
  v_smfmac_f32_16x16x64_bf16 v[60:63], v[24:27], v[192:199], v4
  s_waitcnt lgkmcnt(6)
  v_smfmac_f32_16x16x64_bf16 v[56:59], v[28:31], v[120:127], v4
  v_smfmac_f32_16x16x64_bf16 v[60:63], v[28:31], v[200:207], v4
  s_waitcnt lgkmcnt(5)
  v_smfmac_f32_16x16x64_bf16 v[56:59], v[32:35], v[128:135], v4
  v_smfmac_f32_16x16x64_bf16 v[60:63], v[32:35], v[208:215], v4
  s_waitcnt lgkmcnt(4)
  v_smfmac_f32_16x16x64_bf16 v[56:59], v[36:39], v[136:143], v4
  v_smfmac_f32_16x16x64_bf16 v[60:63], v[36:39], v[216:223], v4
  s_waitcnt lgkmcnt(3)
  v_smfmac_f32_16x16x64_bf16 v[56:59], v[40:43], v[144:151], v4
  v_smfmac_f32_16x16x64_bf16 v[60:63], v[40:43], v[224:231], v4
  s_waitcnt lgkmcnt(2)
  v_smfmac_f32_16x16x64_bf16 v[56:59], v[44:47], v[152:159], v4
  v_smfmac_f32_16x16x64_bf16 v[60:63], v[44:47], v[232:239], v4
  s_waitcnt lgkmcnt(1)
  v_smfmac_f32_16x16x64_bf16 v[56:59], v[48:51], v[160:167], v4
  v_smfmac_f32_16x16x64_bf16 v[60:63], v[48:51], v[240:247], v4
  s_waitcnt lgkmcnt(0)
  v_smfmac_f32_16x16x64_bf16 v[56:59], v[52:55], v[168:175], v4
  v_smfmac_f32_16x16x64_bf16 v[60:63], v[52:55], v[248:255], v4
  s_nop 6
  v_permlane32_swap_b32 v56, v58
  v_permlane32_swap_b32 v57, v59
  v_permlane32_swap_b32 v60, v62
  v_permlane32_swap_b32 v61, v63
  v_pk_add_f32 v[56:57], v[56:57], v[58:59]
  v_pk_add_f32 v[60:61], v[60:61], v[62:63]
  v_cvt_pk_bf16_f32 v56, v56, v57
  v_cvt_pk_bf16_f32 v57, v60, v61
  ds_write_b64 v2, v[56:57]
  s_waitcnt vmcnt(0) lgkmcnt(0)
  s_barrier
  s_cmp_lt_u32 s3, 3
  s_cbranch_scc1 L_qk_tok_S
  s_barrier
  s_add_u32 s59, s48, 1
  s_min_u32 s59, s59, 63
  s_lshr_b32 s59, s59, 1
  s_cmp_gt_u32 s72, s59
  s_cbranch_scc0 L_q1_poll_S
L_q1_go_S:
  buffer_load_dwordx4 v[76:79], v9, s[8:11], s33 offen sc1
  s_sub_u32 s6, s33, 262144
  buffer_load_dwordx4 v[80:83], v9, s[8:11], s6 offen sc1
  s_add_u32 s33, s33, 786432
  s_cmp_eq_u32 s3, 5
  s_cbranch_scc0 L_qk_nx_S
  s_add_u32 s34, s48, 3
  s_and_b32 s34, s34, 3
  s_lshl_b32 s34, s34, 18
  s_add_u32 s34, s34, s79
  s_lshl_b32 s7, s47, 9
  s_add_u32 s7, s7, s34
  s_add_u32 s7, s7, 0x2000
  s_lshl_b32 s6, s47, 2
  s_add_u32 s6, s6, s34
  s_add_u32 s6, s6, 0x2800
  s_mov_b64 exec, s[60:61]
  buffer_store_dwordx4 v[88:91], v5, s[8:11], s7 offen sc1
  buffer_store_dword v88, v5, s[8:11], s6 offen sc1
  s_mov_b64 exec, -1
  s_add_u32 s34, s48, 2
  s_and_b32 s34, s34, 3
  s_lshl_b32 s34, s34, 18
  s_add_u32 s34, s34, s79
  s_lshl_b32 s37, s47, 11
  s_add_u32 s37, s37, s34
  s_add_u32 s37, s37, 0x4000
  s_lshl_b32 s38, s47, 2
  s_add_u32 s38, s38, s34
  s_add_u32 s38, s38, 0x6000
  buffer_store_dwordx4 v[88:91], v9, s[8:11], s37 offen offset:0 sc1
  buffer_store_dwordx4 v[88:91], v9, s[8:11], s37 offen offset:1024 sc1
  buffer_store_dword v88, v9, s[8:11], s38 offen offset:0 sc1
  buffer_store_dword v88, v9, s[8:11], s38 offen offset:1024 sc1
  s_branch L_qk_nx_S
L_qk_tok_S:
  s_nop 15
  s_nop 15
  s_sub_u32 s59, s3, 1
  s_lshl_b32 s6, s59, 10
  v_add_u32 v12, s6, v8
  ds_read_b128 v[16:19], v8 offset:0
  ds_read_b128 v[48:51], v12 offset:8192
  ds_read_b128 v[20:23], v8 offset:2048
  ds_read_b128 v[52:55], v12 offset:10240
  ds_read_b128 v[24:27], v8 offset:4096
  ds_read_b128 v[56:59], v12 offset:12288
  ds_read_b128 v[28:31], v8 offset:6144
  ds_read_b128 v[60:63], v12 offset:14336
  ds_read_b128 v[32:35], v8 offset:1024
  ds_read_b128 v[36:39], v8 offset:3072
  ds_read_b128 v[40:43], v8 offset:5120
  ds_read_b128 v[44:47], v8 offset:7168
  s_waitcnt lgkmcnt(4)
  v_mfma_f32_16x16x32_bf16 v[64:67], v[16:19], v[48:51], 0
  v_mfma_f32_16x16x32_bf16 v[64:67], v[20:23], v[52:55], v[64:67]
  v_mfma_f32_16x16x32_bf16 v[64:67], v[24:27], v[56:59], v[64:67]
  v_mfma_f32_16x16x32_bf16 v[64:67], v[28:31], v[60:63], v[64:67]
  s_waitcnt lgkmcnt(0)
  v_mfma_f32_16x16x32_bf16 v[68:71], v[32:35], v[48:51], 0
  v_mfma_f32_16x16x32_bf16 v[68:71], v[36:39], v[52:55], v[68:71]
  v_mfma_f32_16x16x32_bf16 v[68:71], v[40:43], v[56:59], v[68:71]
  v_mfma_f32_16x16x32_bf16 v[68:71], v[44:47], v[60:63], v[68:71]
  ds_read_b64_tr_b16 v[16:17], v3 offset:0
  ds_read_b64_tr_b16 v[18:19], v3 offset:160
  ds_read_b64_tr_b16 v[20:21], v3 offset:1280
  ds_read_b64_tr_b16 v[22:23], v3 offset:1440
  ds_read_b64_tr_b16 v[24:25], v3 offset:2560
  ds_read_b64_tr_b16 v[26:27], v3 offset:2720
  ds_read_b64_tr_b16 v[28:29], v3 offset:3840
  ds_read_b64_tr_b16 v[30:31], v3 offset:4000
  v_and_b32 v12, 15, v1
  v_lshrrev_b32 v13, 4, v1
  v_lshlrev_b32 v13, 2, v13
  v_sub_u32 v12, v12, v13
  s_mul_i32 s6, s59, 99
  v_add_u32 v13, s6, v12
  v_subrev_u32 v12, 99, v13
  s_waitcnt lgkmcnt(0)
  v_mfma_f32_16x16x32_bf16 v[72:75], v[16:19], v[48:51], 0
  v_mfma_f32_16x16x32_bf16 v[72:75], v[20:23], v[52:55], v[72:75]
  v_mfma_f32_16x16x32_bf16 v[72:75], v[24:27], v[56:59], v[72:75]
  v_mfma_f32_16x16x32_bf16 v[72:75], v[28:31], v[60:63], v[72:75]
  s_barrier
  s_add_u32 s59, s48, 1
  s_min_u32 s59, s59, 63
  s_lshr_b32 s59, s59, 1
  s_cmp_gt_u32 s72, s59
  s_cbranch_scc0 L_q3_poll_S
L_q3_go_S:
  buffer_load_dwordx4 v[76:79], v9, s[8:11], s33 offen sc1
  s_sub_u32 s6, s33, 262144
  buffer_load_dwordx4 v[80:83], v9, s[8:11], s6 offen sc1
  s_add_u32 s33, s33, 786432
  v_mov_b32 v32, 0xff800000
  v_cmp_le_i32 vcc, 0, v13
  s_nop 1
  v_cndmask_b32 v64, v32, v64, vcc
  v_cmp_le_i32 vcc, 1, v13
  s_nop 1
  v_cndmask_b32 v65, v32, v65, vcc
  v_cmp_le_i32 vcc, 2, v13
  s_nop 1
  v_cndmask_b32 v66, v32, v66, vcc
  v_cmp_le_i32 vcc, 3, v13
  s_nop 1
  v_cndmask_b32 v67, v32, v67, vcc
  v_cmp_le_i32 vcc, 0, v12
  s_nop 1
  v_cndmask_b32 v68, v32, v68, vcc
  v_cmp_le_i32 vcc, 1, v12
  s_nop 1
  v_cndmask_b32 v69, v32, v69, vcc
  v_cmp_le_i32 vcc, 2, v12
  s_nop 1
  v_cndmask_b32 v70, v32, v70, vcc
  v_cmp_le_i32 vcc, 3, v12
  s_nop 1
  v_cndmask_b32 v71, v32, v71, vcc
  v_mov_b32 v72, v74
  v_mov_b32 v73, v75
  v_max3_f32 v34, v64, v65, v66
  v_max3_f32 v34, v34, v67, v68
  v_max3_f32 v34, v34, v69, v70
  v_max3_f32 v34, v34, v71, v72
  v_max_f32 v34, v34, v73
  v_mov_b32 v35, v34
  s_nop 1
  v_permlane32_swap_b32 v34, v35
  v_max_f32 v34, v34, v35
  v_mov_b32 v35, v34
  s_nop 1
  v_permlane16_swap_b32 v34, v35
  v_max_f32 v34, v34, v35
  v_mul_f32 v34, s70, v34
  v_fma_f32 v64, v64, s70, -v34
  v_fma_f32 v65, v65, s70, -v34
  v_fma_f32 v66, v66, s70, -v34
  v_fma_f32 v67, v67, s70, -v34
  v_fma_f32 v68, v68, s70, -v34
  v_fma_f32 v69, v69, s70, -v34
  v_fma_f32 v70, v70, s70, -v34
  v_fma_f32 v71, v71, s70, -v34
  v_fma_f32 v72, v72, s70, -v34
  v_fma_f32 v73, v73, s70, -v34
  v_exp_f32 v64, v64
  v_exp_f32 v65, v65
  v_exp_f32 v66, v66
  v_exp_f32 v67, v67
  v_exp_f32 v68, v68
  v_exp_f32 v69, v69
  v_exp_f32 v70, v70
  v_exp_f32 v71, v71
  v_exp_f32 v72, v72
  v_exp_f32 v73, v73
  v_pk_add_f32 v[34:35], v[64:65], v[66:67]
  v_pk_add_f32 v[34:35], v[34:35], v[68:69]
  v_pk_add_f32 v[34:35], v[34:35], v[70:71]
  v_pk_add_f32 v[34:35], v[34:35], v[72:73]
  v_add_f32 v34, v34, v35
  v_mov_b32 v35, v34
  s_nop 1
  v_permlane32_swap_b32 v34, v35
  v_add_f32 v34, v34, v35
  v_mov_b32 v35, v34
  s_nop 1
  v_permlane16_swap_b32 v34, v35
  v_add_f32 v34, v34, v35
  v_rcp_f32 v34, v34
  s_nop 0
  v_pk_mul_f32 v[64:65], v[64:65], v[34:35] op_sel_hi:[1,0]
  v_pk_mul_f32 v[66:67], v[66:67], v[34:35] op_sel_hi:[1,0]
  v_pk_mul_f32 v[68:69], v[68:69], v[34:35] op_sel_hi:[1,0]
  v_pk_mul_f32 v[70:71], v[70:71], v[34:35] op_sel_hi:[1,0]
  v_pk_mul_f32 v[72:73], v[72:73], v[34:35] op_sel_hi:[1,0]
  v_cvt_pk_bf16_f32 v64, v64, v65
  v_cvt_pk_bf16_f32 v65, v66, v67
  v_cvt_pk_bf16_f32 v66, v68, v69
  v_cvt_pk_bf16_f32 v67, v70, v71
  v_cvt_pk_bf16_f32 v68, v72, v73
  v_min_u32 v67, -2, v67
  v_min_u32 v68, -2, v68
  s_lshl_b32 s37, s47, 11
  s_add_u32 s37, s37, s51
  s_add_u32 s37, s37, 0x4000
  s_lshl_b32 s38, s47, 2
  s_add_u32 s38, s38, s51
  s_add_u32 s38, s38, 0x6000
  s_sub_u32 s6, s3, 1
  s_lshl_b32 s6, s6, 10
  s_add_u32 s37, s37, s6
  s_add_u32 s38, s38, s6
  buffer_store_dwordx4 v[64:67], v9, s[8:11], s37 offen sc1
  buffer_store_dword v68, v9, s[8:11], s38 offen sc1
  s_branch L_qk_nx_S
L_qk_w0_S:
  ds_read_b128 v[16:19], v9 offset:0
  ds_read_b128 v[20:23], v9 offset:1024
  ds_read_b128 v[24:27], v9 offset:2048
  ds_read_b128 v[28:31], v9 offset:3072
  ds_read_b128 v[32:35], v9 offset:4096
  ds_read_b128 v[36:39], v9 offset:5120
  ds_read_b128 v[40:43], v9 offset:6144
  ds_read_b128 v[44:47], v9 offset:7168
  ds_read_b128 v[48:51], v9 offset:8192
  ds_read_b128 v[52:55], v9 offset:9216
  s_waitcnt lgkmcnt(9)
  v_smfmac_f32_16x16x64_bf16 v[56:59], v[16:19], v[96:103], v4
  v_smfmac_f32_16x16x64_bf16 v[60:63], v[16:19], v[176:183], v4
  s_waitcnt lgkmcnt(8)
  v_smfmac_f32_16x16x64_bf16 v[56:59], v[20:23], v[104:111], v4
  v_smfmac_f32_16x16x64_bf16 v[60:63], v[20:23], v[184:191], v4
  s_waitcnt lgkmcnt(7)
  v_smfmac_f32_16x16x64_bf16 v[56:59], v[24:27], v[112:119], v4
  v_smfmac_f32_16x16x64_bf16 v[60:63], v[24:27], v[192:199], v4
  s_waitcnt lgkmcnt(6)
  v_smfmac_f32_16x16x64_bf16 v[56:59], v[28:31], v[120:127], v4
  v_smfmac_f32_16x16x64_bf16 v[60:63], v[28:31], v[200:207], v4
  s_waitcnt lgkmcnt(5)
  v_smfmac_f32_16x16x64_bf16 v[56:59], v[32:35], v[128:135], v4
  v_smfmac_f32_16x16x64_bf16 v[60:63], v[32:35], v[208:215], v4
  s_waitcnt lgkmcnt(4)
  v_smfmac_f32_16x16x64_bf16 v[56:59], v[36:39], v[136:143], v4
  v_smfmac_f32_16x16x64_bf16 v[60:63], v[36:39], v[216:223], v4
  s_waitcnt lgkmcnt(3)
  v_smfmac_f32_16x16x64_bf16 v[56:59], v[40:43], v[144:151], v4
  v_smfmac_f32_16x16x64_bf16 v[60:63], v[40:43], v[224:231], v4
  s_waitcnt lgkmcnt(2)
  v_smfmac_f32_16x16x64_bf16 v[56:59], v[44:47], v[152:159], v4
  v_smfmac_f32_16x16x64_bf16 v[60:63], v[44:47], v[232:239], v4
  s_waitcnt lgkmcnt(1)
  v_smfmac_f32_16x16x64_bf16 v[56:59], v[48:51], v[160:167], v4
  v_smfmac_f32_16x16x64_bf16 v[60:63], v[48:51], v[240:247], v4
  s_waitcnt lgkmcnt(0)
  v_smfmac_f32_16x16x64_bf16 v[56:59], v[52:55], v[168:175], v4
  v_smfmac_f32_16x16x64_bf16 v[60:63], v[52:55], v[248:255], v4
  s_nop 6
  v_permlane32_swap_b32 v56, v58
  v_permlane32_swap_b32 v57, v59
  v_permlane32_swap_b32 v60, v62
  v_permlane32_swap_b32 v61, v63
  v_pk_add_f32 v[56:57], v[56:57], v[58:59]
  v_pk_add_f32 v[60:61], v[60:61], v[62:63]
  v_cvt_pk_bf16_f32 v56, v56, v57
  v_cvt_pk_bf16_f32 v57, v60, v61
  ds_write_b64 v2, v[56:57]
  ds_read_b128 v[16:19], v8 offset:0
  ds_read_b128 v[20:23], v8 offset:1024
  ds_read_b128 v[24:27], v8 offset:2048
  ds_read_b128 v[28:31], v8 offset:3072
  ds_read_b128 v[32:35], v8 offset:4096
  ds_read_b128 v[36:39], v8 offset:5120
  ds_read_b128 v[40:43], v8 offset:6144
  ds_read_b128 v[44:47], v8 offset:7168
  s_lshl_b32 s53, s47, 9
  s_add_u32 s53, s53, s51
  s_add_u32 s53, s53, 0x2000
  s_lshl_b32 s54, s47, 2
  s_add_u32 s54, s54, s51
  s_add_u32 s54, s54, 0x2800
  s_mov_b64 vcc, s[64:65]
  s_cmp_eq_u32 s48, 63
  s_waitcnt lgkmcnt(8)
  s_barrier
  ds_read_b64_tr_b16 v[48:49], v3 offset:0
  ds_read_b64_tr_b16 v[50:51], v3 offset:160
  ds_read_b64_tr_b16 v[52:53], v3 offset:1280
  ds_read_b64_tr_b16 v[54:55], v3 offset:1440
  ds_read_b64_tr_b16 v[56:57], v3 offset:2560
  ds_read_b64_tr_b16 v[58:59], v3 offset:2720
  ds_read_b64_tr_b16 v[60:61], v3 offset:3840
  ds_read_b64_tr_b16 v[62:63], v3 offset:4000
  s_cbranch_scc1 L_qk_bp_S
  s_waitcnt vmcnt(0)
  s_waitcnt lgkmcnt(6)
  v_mfma_f32_16x16x32_bf16 v[72:75], v[16:19], v[48:51], 0
  v_mfma_f32_16x16x32_bf16 v[76:79], v[20:23], v[48:51], 0
  v_mfma_f32_16x16x32_bf16 v[80:83], v[48:51], v[48:51], 0
  s_waitcnt lgkmcnt(4)
  v_mfma_f32_16x16x32_bf16 v[72:75], v[24:27], v[52:55], v[72:75]
  v_mfma_f32_16x16x32_bf16 v[76:79], v[28:31], v[52:55], v[76:79]
  v_mfma_f32_16x16x32_bf16 v[80:83], v[52:55], v[52:55], v[80:83]
  s_waitcnt lgkmcnt(2)
  v_mfma_f32_16x16x32_bf16 v[72:75], v[32:35], v[56:59], v[72:75]
  v_mfma_f32_16x16x32_bf16 v[76:79], v[36:39], v[56:59], v[76:79]
  v_mfma_f32_16x16x32_bf16 v[80:83], v[56:59], v[56:59], v[80:83]
  s_waitcnt lgkmcnt(0)
  v_mfma_f32_16x16x32_bf16 v[72:75], v[40:43], v[60:63], v[72:75]
  v_mfma_f32_16x16x32_bf16 v[76:79], v[44:47], v[60:63], v[76:79]
  v_mfma_f32_16x16x32_bf16 v[80:83], v[60:63], v[60:63], v[80:83]
  s_nop 6
  v_cndmask_b32 v72, v76, v72, vcc quad_perm:[0,1,0,1] row_mask:0xf bank_mask:0xf
  v_cndmask_b32 v73, v77, v73, vcc quad_perm:[0,1,0,1] row_mask:0xf bank_mask:0xf
  v_cndmask_b32 v74, v78, v74, vcc quad_perm:[0,1,0,1] row_mask:0xf bank_mask:0xf
  v_cndmask_b32 v75, v79, v75, vcc quad_perm:[0,1,0,1] row_mask:0xf bank_mask:0xf
  v_cndmask_b32 v76, v83, v82, vcc quad_perm:[0,1,0,1] row_mask:0xf bank_mask:0xf
  v_max3_f32 v16, v72, v73, v74
  v_max3_f32 v16, v16, v75, v76
  v_mul_f32 v18, s70, v16
  v_fma_f32 v72, v72, s70, -v18
  v_max_f32 v16, v16, v16 quad_perm:[2,3,0,1] row_mask:0xf bank_mask:0xf
  v_fma_f32 v73, v73, s70, -v18
  v_mov_b32 v17, v16
  v_fma_f32 v74, v74, s70, -v18
  v_fma_f32 v75, v75, s70, -v18
  v_permlane32_swap_b32 v16, v17
  v_fma_f32 v76, v76, s70, -v18
  v_max_f32 v16, v16, v17
  v_exp_f32 v72, v72
  v_mov_b32 v17, v16
  v_exp_f32 v73, v73
  v_exp_f32 v74, v74
  v_permlane16_swap_b32 v16, v17
  v_exp_f32 v75, v75
  v_max_f32 v16, v16, v17
  v_exp_f32 v76, v76
  v_fma_f32 v20, -v16, s70, v18
  v_exp_f32 v20, v20
  v_pk_add_f32 v[78:79], v[72:73], v[74:75]
  v_add_f32 v16, v76, v78
  v_mul_f32 v76, v76, v20
  v_add_f32 v16, v16, v79
  v_mul_f32 v16, v16, v20
  v_mov_b32 v77, v76 quad_perm:[2,3,0,1] row_mask:0xf bank_mask:0xf
  s_nop 0
  v_add_f32 v16, v16, v16 quad_perm:[2,3,0,1] row_mask:0xf bank_mask:0xf
  v_mov_b32 v17, v16
  s_nop 1
  v_permlane32_swap_b32 v16, v17
  v_add_f32 v16, v16, v17
  v_mov_b32 v17, v16
  s_nop 1
  v_permlane16_swap_b32 v16, v17
  v_add_f32 v16, v16, v17
  v_rcp_f32 v16, v16
  s_nop 0
  v_mul_f32 v20, v20, v16
  v_pk_mul_f32 v[76:77], v[76:77], v[16:17] op_sel_hi:[1,0]
  v_pk_mul_f32 v[72:73], v[72:73], v[20:21] op_sel_hi:[1,0]
  v_pk_mul_f32 v[74:75], v[74:75], v[20:21] op_sel_hi:[1,0]
  v_cvt_pk_bf16_f32 v78, v72, v73
  v_cvt_pk_bf16_f32 v79, v74, v75
  v_cvt_pk_bf16_f32 v80, v76, v77
  v_min_u32 v79, -2, v79
  v_min_u32 v80, -2, v80
  buffer_store_dwordx2 v[78:79], v7, s[8:11], s53 offen sc1
  s_mov_b64 exec, s[64:65]
  buffer_store_dword v80, v86, s[8:11], s54 offen sc1
  s_mov_b64 exec, -1
L_qk_bp_S:
  s_barrier
  s_add_u32 s59, s48, 1
  s_min_u32 s59, s59, 63
  s_lshr_b32 s59, s59, 1
  s_cmp_gt_u32 s72, s59
  s_cbranch_scc0 L_q2_poll_S
L_q2_go_S:
  buffer_load_dwordx4 v[76:79], v9, s[8:11], s33 offen sc1
  s_sub_u32 s6, s33, 262144
  buffer_load_dwordx4 v[80:83], v9, s[8:11], s6 offen sc1
  s_add_u32 s33, s33, 786432
L_qk_nx_S:
  s_cmp_eq_u32 s48, 63
  s_cbranch_scc1 L_qk_last_S
  s_add_u32 s48, s48, 1
L_qk_k_S:
  s_and_b32 s57, s48, 3
  s_lshl_b32 s50, s57, 16
  s_lshl_b32 s51, s57, 18
  s_add_u32 s50, s50, s78
  s_add_u32 s51, s51, s79
  s_add_u32 s50, s50, s75
  s_mov_b32 s56, 524288
  v_xor_b32 v8, 0xc000, v8
  v_xor_b32 v6, 0xc000, v6
  s_waitcnt vmcnt(0)
  ds_write_b128 v6, v[76:79]
  ds_write_b128 v6, v[80:83] offset:8192
  s_waitcnt lgkmcnt(0)
  s_barrier
  s_cmp_eq_u32 s3, 6
  s_cbranch_scc0 L_qk_nf_S
L_qk_nf_S:
  s_cmp_eq_u32 s48, 0
  s_cbranch_scc0 L_qk_top_S
  v_mov_b32 v56, 0
  v_mov_b32 v57, 0
  v_mov_b32 v58, 0
  v_mov_b32 v59, 0
  v_mov_b32 v60, 0
  v_mov_b32 v61, 0
  v_mov_b32 v62, 0
  v_mov_b32 v63, 0
  s_branch L_qk_first_S
L_qk_last_S:
  s_cmp_eq_u32 s3, 6
  s_cbranch_scc0 L_END
  s_endpgm
L_qm_t_S:
  buffer_load_dwordx4 v[72:75], v9, s[8:11], s50 offen sc1
  buffer_load_dword v76, v0, s[8:11], s50 offen offset:1024 sc1
  s_waitcnt vmcnt(2)
  v_max3_u32 v14, v78, v79, v80
  v_max3_u32 v14, v14, v81, v82
  v_cmp_eq_u32 vcc, -1, v14
  s_cbranch_vccz L_qm_b_S
  s_sub_u32 s56, s56, 1
  s_cmp_lg_u32 s56, 0
  s_cbranch_scc1 L_qm_l_S
  s_endpgm
L_qm_b_S:
  ds_write_b128 v11, v[78:81]
  ds_write_b32 v10, v82 offset:1024
  s_branch L_qm_o_S
L_q0_poll_S:
  buffer_load_dword v14, v95, s[8:11], 0 offen sc1
  s_waitcnt vmcnt(0)
  v_min_u32 v14, v14, v14 row_ror:8 row_mask:0xf bank_mask:0xf
  s_nop 1
  v_min_u32 v14, v14, v14 row_ror:4 row_mask:0xf bank_mask:0xf
  s_nop 1
  v_min_u32 v14, v14, v14 row_ror:2 row_mask:0xf bank_mask:0xf
  s_nop 1
  v_min_u32 v14, v14, v14 row_ror:1 row_mask:0xf bank_mask:0xf
  s_nop 0
  v_readfirstlane_b32 s72, v14
  s_cmp_gt_u32 s72, s59
  s_cbranch_scc1 L_q0_go_S
  s_sleep 2
  s_sub_u32 s56, s56, 1
  s_cmp_lg_u32 s56, 0
  s_cbranch_scc1 L_q0_poll_S
  s_endpgm
L_q1_poll_S:
  buffer_load_dword v14, v95, s[8:11], 0 offen sc1
  s_waitcnt vmcnt(0)
  v_min_u32 v14, v14, v14 row_ror:8 row_mask:0xf bank_mask:0xf
  s_nop 1
  v_min_u32 v14, v14, v14 row_ror:4 row_mask:0xf bank_mask:0xf
  s_nop 1
  v_min_u32 v14, v14, v14 row_ror:2 row_mask:0xf bank_mask:0xf
  s_nop 1
  v_min_u32 v14, v14, v14 row_ror:1 row_mask:0xf bank_mask:0xf
  s_nop 0
  v_readfirstlane_b32 s72, v14
  s_cmp_gt_u32 s72, s59
  s_cbranch_scc1 L_q1_go_S
  s_sleep 2
  s_sub_u32 s56, s56, 1
  s_cmp_lg_u32 s56, 0
  s_cbranch_scc1 L_q1_poll_S
  s_endpgm
L_q3_poll_S:
  buffer_load_dword v14, v95, s[8:11], 0 offen sc1
  s_waitcnt vmcnt(0)
  v_min_u32 v14, v14, v14 row_ror:8 row_mask:0xf bank_mask:0xf
  s_nop 1
  v_min_u32 v14, v14, v14 row_ror:4 row_mask:0xf bank_mask:0xf
  s_nop 1
  v_min_u32 v14, v14, v14 row_ror:2 row_mask:0xf bank_mask:0xf
  s_nop 1
  v_min_u32 v14, v14, v14 row_ror:1 row_mask:0xf bank_mask:0xf
  s_nop 0
  v_readfirstlane_b32 s72, v14
  s_cmp_gt_u32 s72, s59
  s_cbranch_scc1 L_q3_go_S
  s_sleep 2
  s_sub_u32 s56, s56, 1
  s_cmp_lg_u32 s56, 0
  s_cbranch_scc1 L_q3_poll_S
  s_endpgm
L_q2_poll_S:
  buffer_load_dword v14, v95, s[8:11], 0 offen sc1
  s_waitcnt vmcnt(0)
  v_min_u32 v14, v14, v14 row_ror:8 row_mask:0xf bank_mask:0xf
  s_nop 1
  v_min_u32 v14, v14, v14 row_ror:4 row_mask:0xf bank_mask:0xf
  s_nop 1
  v_min_u32 v14, v14, v14 row_ror:2 row_mask:0xf bank_mask:0xf
  s_nop 1
  v_min_u32 v14, v14, v14 row_ror:1 row_mask:0xf bank_mask:0xf
  s_nop 0
  v_readfirstlane_b32 s72, v14
  s_cmp_gt_u32 s72, s59
  s_cbranch_scc1 L_q2_go_S
  s_sleep 2
  s_sub_u32 s56, s56, 1
  s_cmp_lg_u32 s56, 0
  s_cbranch_scc1 L_q2_poll_S
  s_endpgm
L_VCU:
  s_sub_u32 s39, s47, 4
  s_lshl_b32 s36, s39, 12
  s_lshl_b32 s49, s46, 1
  s_add_u32 s39, s39, s49
  s_lshl_b32 s49, s39, 1
  s_lshl_b32 s58, s49, 8
  s_mov_b32 s20, s42
  s_mov_b32 s21, s43
  v_lshrrev_b32 v12, 4, v1
  v_lshlrev_b32 v13, 13, v12
  v_and_b32 v12, 1, v12
  v_lshlrev_b32 v12, 1, v12
  v_and_b32 v20, 15, v1
  v_xor_b32 v12, v12, v20
  v_xor_b32 v20, 0, v12
  v_and_b32 v21, 14, v20
  v_add_u32 v20, v20, v21
  v_lshl_add_u32 v16, v20, 4, v13
  v_xor_b32 v20, 8, v12
  v_and_b32 v21, 14, v20
  v_add_u32 v20, v20, v21
  v_lshl_add_u32 v17, v20, 4, v13
  v_xor_b32 v20, 4, v12
  v_and_b32 v21, 14, v20
  v_add_u32 v20, v20, v21
  v_lshl_add_u32 v18, v20, 4, v13
  v_xor_b32 v20, 12, v12
  v_and_b32 v21, 14, v20
  v_add_u32 v20, v20, v21
  v_lshl_add_u32 v19, v20, 4, v13
  v_bfe_u32 v12, v1, 5, 1
  v_lshlrev_b32 v12, 4, v12
  v_bfe_u32 v13, v1, 4, 1
  v_lshl_add_u32 v12, v13, 2, v12
  v_lshlrev_b32 v22, 2, v13
  v_bfe_u32 v13, v1, 2, 1
  v_add_u32 v12, v12, v13
  v_add_u32 v22, v22, v13
  v_bfe_u32 v13, v1, 3, 1
  v_lshl_add_u32 v12, v13, 3, v12
  v_lshl_add_u32 v22, v13, 1, v22
  v_lshlrev_b32 v12, 8, v12
  v_and_b32 v13, 3, v1
  v_lshl_add_u32 v21, v13, 3, v12
  s_mul_i32 s6, s3, 20480
  s_mul_i32 s7, s3, 655360
  s_add_u32 s7, s7, s58
  s_add_u32 s59, s7, 32
  s_mov_b32 m0, s6
  s_add_u32 s6, s6, 1024
  buffer_load_dwordx4 v16, s[20:23], s7 offen lds
  s_add_u32 s7, s7, 32768
  s_mov_b32 m0, s6
  s_add_u32 s6, s6, 1024
  buffer_load_dwordx4 v17, s[20:23], s7 offen lds
  s_add_u32 s7, s7, 32768
  s_mov_b32 m0, s6
  s_add_u32 s6, s6, 1024
  buffer_load_dwordx4 v18, s[20:23], s7 offen lds
  s_add_u32 s7, s7, 32768
  s_mov_b32 m0, s6
  s_add_u32 s6, s6, 1024
  buffer_load_dwordx4 v19, s[20:23], s7 offen lds
  s_add_u32 s7, s7, 32768
  s_mov_b32 m0, s6
  s_add_u32 s6, s6, 1024
  buffer_load_dwordx4 v16, s[20:23], s7 offen lds
  s_add_u32 s7, s7, 32768
  s_mov_b32 m0, s6
  s_add_u32 s6, s6, 1024
  buffer_load_dwordx4 v17, s[20:23], s7 offen lds
  s_add_u32 s7, s7, 32768
  s_mov_b32 m0, s6
  s_add_u32 s6, s6, 1024
  buffer_load_dwordx4 v18, s[20:23], s7 offen lds
  s_add_u32 s7, s7, 32768
  s_mov_b32 m0, s6
  s_add_u32 s6, s6, 1024
  buffer_load_dwordx4 v19, s[20:23], s7 offen lds
  s_add_u32 s7, s7, 32768
  s_mov_b32 m0, s6
  s_add_u32 s6, s6, 1024
  buffer_load_dwordx4 v16, s[20:23], s7 offen lds
  s_add_u32 s7, s7, 32768
  s_mov_b32 m0, s6
  s_add_u32 s6, s6, 1024
  buffer_load_dwordx4 v17, s[20:23], s7 offen lds
  s_add_u32 s7, s7, 32768
  s_mov_b32 m0, s6
  s_add_u32 s6, s6, 1024
  buffer_load_dwordx4 v18, s[20:23], s7 offen lds
  s_add_u32 s7, s7, 32768
  s_mov_b32 m0, s6
  s_add_u32 s6, s6, 1024
  buffer_load_dwordx4 v19, s[20:23], s7 offen lds
  s_add_u32 s7, s7, 32768
  s_mov_b32 m0, s6
  s_add_u32 s6, s6, 1024
  buffer_load_dwordx4 v16, s[20:23], s7 offen lds
  s_add_u32 s7, s7, 32768
  s_mov_b32 m0, s6
  s_add_u32 s6, s6, 1024
  buffer_load_dwordx4 v17, s[20:23], s7 offen lds
  s_add_u32 s7, s7, 32768
  s_mov_b32 m0, s6
  s_add_u32 s6, s6, 1024
  buffer_load_dwordx4 v18, s[20:23], s7 offen lds
  s_add_u32 s7, s7, 32768
  s_mov_b32 m0, s6
  s_add_u32 s6, s6, 1024
  buffer_load_dwordx4 v19, s[20:23], s7 offen lds
  s_add_u32 s7, s7, 32768
  s_mov_b32 m0, s6
  s_add_u32 s6, s6, 1024
  buffer_load_dwordx4 v16, s[20:23], s7 offen lds
  s_add_u32 s7, s7, 32768
  s_mov_b32 m0, s6
  s_add_u32 s6, s6, 1024
  buffer_load_dwordx4 v17, s[20:23], s7 offen lds
  s_add_u32 s7, s7, 32768
  s_mov_b32 m0, s6
  s_add_u32 s6, s6, 1024
  buffer_load_dwordx4 v18, s[20:23], s7 offen lds
  s_add_u32 s7, s7, 32768
  s_mov_b32 m0, s6
  s_add_u32 s6, s6, 1024
  buffer_load_dwordx4 v19, s[20:23], s7 offen lds
  s_add_u32 s7, s7, 32768
  s_mov_b32 s20, s42
  s_mov_b32 s21, s43
  buffer_load_dwordx4 v[176:179], v16, s[20:23], s59 offen
  s_add_u32 s59, s59, 32768
  buffer_load_dwordx4 v[180:183], v17, s[20:23], s59 offen
  s_add_u32 s59, s59, 32768
  buffer_load_dwordx4 v[184:187], v18, s[20:23], s59 offen
  s_add_u32 s59, s59, 32768
  buffer_load_dwordx4 v[188:191], v19, s[20:23], s59 offen
  s_add_u32 s59, s59, 32768
  buffer_load_dwordx4 v[192:195], v16, s[20:23], s59 offen
  s_add_u32 s59, s59, 32768
  buffer_load_dwordx4 v[196:199], v17, s[20:23], s59 offen
  s_add_u32 s59, s59, 32768
  buffer_load_dwordx4 v[200:203], v18, s[20:23], s59 offen
  s_add_u32 s59, s59, 32768
  buffer_load_dwordx4 v[204:207], v19, s[20:23], s59 offen
  s_add_u32 s59, s59, 32768
  buffer_load_dwordx4 v[208:211], v16, s[20:23], s59 offen
  s_add_u32 s59, s59, 32768
  buffer_load_dwordx4 v[212:215], v17, s[20:23], s59 offen
  s_add_u32 s59, s59, 32768
  buffer_load_dwordx4 v[216:219], v18, s[20:23], s59 offen
  s_add_u32 s59, s59, 32768
  buffer_load_dwordx4 v[220:223], v19, s[20:23], s59 offen
  s_add_u32 s59, s59, 32768
  buffer_load_dwordx4 v[224:227], v16, s[20:23], s59 offen
  s_add_u32 s59, s59, 32768
  buffer_load_dwordx4 v[228:231], v17, s[20:23], s59 offen
  s_add_u32 s59, s59, 32768
  buffer_load_dwordx4 v[232:235], v18, s[20:23], s59 offen
  s_add_u32 s59, s59, 32768
  buffer_load_dwordx4 v[236:239], v19, s[20:23], s59 offen
  s_add_u32 s59, s59, 32768
  buffer_load_dwordx4 v[240:243], v16, s[20:23], s59 offen
  s_add_u32 s59, s59, 32768
  buffer_load_dwordx4 v[244:247], v17, s[20:23], s59 offen
  s_add_u32 s59, s59, 32768
  buffer_load_dwordx4 v[248:251], v18, s[20:23], s59 offen
  s_add_u32 s59, s59, 32768
  buffer_load_dwordx4 v[252:255], v19, s[20:23], s59 offen
  s_add_u32 s59, s59, 32768
  s_waitcnt vmcnt(20)
  s_barrier
  v_xor_b32 v12, s3, v22
  v_lshl_add_u32 v12, v12, 5, v21
  v_add_u32 v13, 0xc000, v12
  v_add_u32 v20, 0x18000, v12
  v_add_u32 v23, 0x24000, v12
  ds_read_b64_tr_b16 v[96:97], v12 offset:0
  ds_read_b64_tr_b16 v[98:99], v12 offset:512
  ds_read_b64_tr_b16 v[100:101], v12 offset:8192
  ds_read_b64_tr_b16 v[102:103], v12 offset:8704
  ds_read_b64_tr_b16 v[104:105], v12 offset:16384
  ds_read_b64_tr_b16 v[106:107], v12 offset:16896
  ds_read_b64_tr_b16 v[108:109], v12 offset:24576
  ds_read_b64_tr_b16 v[110:111], v12 offset:25088
  s_waitcnt lgkmcnt(0)
  ds_read_b64_tr_b16 v[112:113], v12 offset:32768
  ds_read_b64_tr_b16 v[114:115], v12 offset:33280
  ds_read_b64_tr_b16 v[116:117], v12 offset:40960
  ds_read_b64_tr_b16 v[118:119], v12 offset:41472
  ds_read_b64_tr_b16 v[120:121], v13 offset:0
  ds_read_b64_tr_b16 v[122:123], v13 offset:512
  ds_read_b64_tr_b16 v[124:125], v13 offset:8192
  ds_read_b64_tr_b16 v[126:127], v13 offset:8704
  s_waitcnt lgkmcnt(0)
  ds_read_b64_tr_b16 v[128:129], v13 offset:16384
  ds_read_b64_tr_b16 v[130:131], v13 offset:16896
  ds_read_b64_tr_b16 v[132:133], v13 offset:24576
  ds_read_b64_tr_b16 v[134:135], v13 offset:25088
  ds_read_b64_tr_b16 v[136:137], v13 offset:32768
  ds_read_b64_tr_b16 v[138:139], v13 offset:33280
  ds_read_b64_tr_b16 v[140:141], v13 offset:40960
  ds_read_b64_tr_b16 v[142:143], v13 offset:41472
  s_waitcnt lgkmcnt(0)
  ds_read_b64_tr_b16 v[144:145], v20 offset:0
  ds_read_b64_tr_b16 v[146:147], v20 offset:512
  ds_read_b64_tr_b16 v[148:149], v20 offset:8192
  ds_read_b64_tr_b16 v[150:151], v20 offset:8704
  ds_read_b64_tr_b16 v[152:153], v20 offset:16384
  ds_read_b64_tr_b16 v[154:155], v20 offset:16896
  ds_read_b64_tr_b16 v[156:157], v20 offset:24576
  ds_read_b64_tr_b16 v[158:159], v20 offset:25088
  s_waitcnt lgkmcnt(0)
  ds_read_b64_tr_b16 v[160:161], v20 offset:32768
  ds_read_b64_tr_b16 v[162:163], v20 offset:33280
  ds_read_b64_tr_b16 v[164:165], v20 offset:40960
  ds_read_b64_tr_b16 v[166:167], v20 offset:41472
  ds_read_b64_tr_b16 v[168:169], v23 offset:0
  ds_read_b64_tr_b16 v[170:171], v23 offset:512
  ds_read_b64_tr_b16 v[172:173], v23 offset:8192
  ds_read_b64_tr_b16 v[174:175], v23 offset:8704
  s_waitcnt lgkmcnt(0)
  s_barrier
  s_mul_i32 s6, s3, 20480
  v_add_u32 v12, s6, v9
  s_waitcnt vmcnt(19)
  ds_write_b128 v12, v[176:179] offset:0
  s_waitcnt vmcnt(18)
  ds_write_b128 v12, v[180:183] offset:1024
  s_waitcnt vmcnt(17)
  ds_write_b128 v12, v[184:187] offset:2048
  s_waitcnt vmcnt(16)
  ds_write_b128 v12, v[188:191] offset:3072
  s_waitcnt vmcnt(15)
  ds_write_b128 v12, v[192:195] offset:4096
  s_waitcnt vmcnt(14)
  ds_write_b128 v12, v[196:199] offset:5120
  s_waitcnt vmcnt(13)
  ds_write_b128 v12, v[200:203] offset:6144
  s_waitcnt vmcnt(12)
  ds_write_b128 v12, v[204:207] offset:7168
  s_waitcnt vmcnt(11)
  ds_write_b128 v12, v[208:211] offset:8192
  s_waitcnt vmcnt(10)
  ds_write_b128 v12, v[212:215] offset:9216
  s_waitcnt vmcnt(9)
  ds_write_b128 v12, v[216:219] offset:10240
  s_waitcnt vmcnt(8)
  ds_write_b128 v12, v[220:223] offset:11264
  s_waitcnt vmcnt(7)
  ds_write_b128 v12, v[224:227] offset:12288
  s_waitcnt vmcnt(6)
  ds_write_b128 v12, v[228:231] offset:13312
  s_waitcnt vmcnt(5)
  ds_write_b128 v12, v[232:235] offset:14336
  s_waitcnt vmcnt(4)
  ds_write_b128 v12, v[236:239] offset:15360
  s_waitcnt vmcnt(3)
  ds_write_b128 v12, v[240:243] offset:16384
  s_waitcnt vmcnt(2)
  ds_write_b128 v12, v[244:247] offset:17408
  s_waitcnt vmcnt(1)
  ds_write_b128 v12, v[248:251] offset:18432
  s_waitcnt vmcnt(0)
  ds_write_b128 v12, v[252:255] offset:19456
  s_waitcnt lgkmcnt(0)
  s_barrier
  v_xor_b32 v12, s3, v22
  v_lshl_add_u32 v12, v12, 5, v21
  v_add_u32 v13, 0xc000, v12
  v_add_u32 v20, 0x18000, v12
  v_add_u32 v23, 0x24000, v12
  ds_read_b64_tr_b16 v[176:177], v12 offset:0
  ds_read_b64_tr_b16 v[178:179], v12 offset:512
  ds_read_b64_tr_b16 v[180:181], v12 offset:8192
  ds_read_b64_tr_b16 v[182:183], v12 offset:8704
  ds_read_b64_tr_b16 v[184:185], v12 offset:16384
  ds_read_b64_tr_b16 v[186:187], v12 offset:16896
  ds_read_b64_tr_b16 v[188:189], v12 offset:24576
  ds_read_b64_tr_b16 v[190:191], v12 offset:25088
  s_waitcnt lgkmcnt(0)
  ds_read_b64_tr_b16 v[192:193], v12 offset:32768
  ds_read_b64_tr_b16 v[194:195], v12 offset:33280
  ds_read_b64_tr_b16 v[196:197], v12 offset:40960
  ds_read_b64_tr_b16 v[198:199], v12 offset:41472
  ds_read_b64_tr_b16 v[200:201], v13 offset:0
  ds_read_b64_tr_b16 v[202:203], v13 offset:512
  ds_read_b64_tr_b16 v[204:205], v13 offset:8192
  ds_read_b64_tr_b16 v[206:207], v13 offset:8704
  s_waitcnt lgkmcnt(0)
  ds_read_b64_tr_b16 v[208:209], v13 offset:16384
  ds_read_b64_tr_b16 v[210:211], v13 offset:16896
  ds_read_b64_tr_b16 v[212:213], v13 offset:24576
  ds_read_b64_tr_b16 v[214:215], v13 offset:25088
  ds_read_b64_tr_b16 v[216:217], v13 offset:32768
  ds_read_b64_tr_b16 v[218:219], v13 offset:33280
  ds_read_b64_tr_b16 v[220:221], v13 offset:40960
  ds_read_b64_tr_b16 v[222:223], v13 offset:41472
  s_waitcnt lgkmcnt(0)
  ds_read_b64_tr_b16 v[224:225], v20 offset:0
  ds_read_b64_tr_b16 v[226:227], v20 offset:512
  ds_read_b64_tr_b16 v[228:229], v20 offset:8192
  ds_read_b64_tr_b16 v[230:231], v20 offset:8704
  ds_read_b64_tr_b16 v[232:233], v20 offset:16384
  ds_read_b64_tr_b16 v[234:235], v20 offset:16896
  ds_read_b64_tr_b16 v[236:237], v20 offset:24576
  ds_read_b64_tr_b16 v[238:239], v20 offset:25088
  s_waitcnt lgkmcnt(0)
  ds_read_b64_tr_b16 v[240:241], v20 offset:32768
  ds_read_b64_tr_b16 v[242:243], v20 offset:33280
  ds_read_b64_tr_b16 v[244:245], v20 offset:40960
  ds_read_b64_tr_b16 v[246:247], v20 offset:41472
  ds_read_b64_tr_b16 v[248:249], v23 offset:0
  ds_read_b64_tr_b16 v[250:251], v23 offset:512
  ds_read_b64_tr_b16 v[252:253], v23 offset:8192
  ds_read_b64_tr_b16 v[254:255], v23 offset:8704
  s_waitcnt lgkmcnt(0)
  v_mov_b32 v12, 0x4444
  v_mov_b32 v13, 0xeeee
  v_cndmask_b32 v4, v12, v13, s[62:63]
  s_mul_i32 s75, s3, 1280
  v_add_u32 v11, s75, v9
  v_lshlrev_b32 v0, 2, v1
  v_add_u32 v10, s75, v0
  v_lshrrev_b32 v12, 4, v1
  v_lshlrev_b32 v12, 3, v12
  v_bfe_u32 v13, v1, 2, 2
  v_add_u32 v12, v12, v13
  v_mul_u32_u24 v12, 40, v12
  v_and_b32 v13, 3, v1
  v_lshl_add_u32 v3, v13, 3, v12
  v_and_b32 v12, 15, v1
  v_mul_u32_u24 v12, 40, v12
  v_bfe_u32 v13, v1, 4, 1
  v_lshl_add_u32 v12, v13, 4, v12
  v_lshrrev_b32 v13, 5, v1
  v_lshl_add_u32 v2, v13, 3, v12
  v_lshrrev_b32 v12, 4, v1
  v_lshlrev_b32 v12, 7, v12
  v_bfe_u32 v13, v1, 2, 2
  v_lshl_add_u32 v12, v13, 5, v12
  v_and_b32 v13, 1, v1
  v_lshl_add_u32 v86, v13, 4, v12
  s_mul_i32 s6, s3, 640
  s_add_u32 s6, s6, 10240
  v_add_u32 v2, s6, v2
  v_add_u32 v3, 10240, v3
  v_lshlrev_b32 v12, 5, v1
  s_mov_b32 s59, 65536
L_rdy_2058:
  buffer_load_dword v13, v12, s[12:15], 0 offen offset:4 sc1
  s_waitcnt vmcnt(0)
  v_readlane_b32 s57, v13, 0
  v_readlane_b32 s58, v13, 1
  s_add_u32 s57, s57, s58
  v_readlane_b32 s58, v13, 2
  s_add_u32 s57, s57, s58
  v_readlane_b32 s58, v13, 3
  s_add_u32 s57, s57, s58
  v_readlane_b32 s58, v13, 4
  s_add_u32 s57, s57, s58
  v_readlane_b32 s58, v13, 5
  s_add_u32 s57, s57, s58
  v_readlane_b32 s58, v13, 6
  s_add_u32 s57, s57, s58
  v_readlane_b32 s58, v13, 7
  s_add_u32 s57, s57, s58
  s_cmp_ge_u32 s57, 256
  s_cbranch_scc1 L_rdyd_2059
  s_sleep 8
  s_sub_u32 s59, s59, 1
  s_cmp_lg_u32 s59, 0
  s_cbranch_scc1 L_rdy_2058
  s_endpgm
L_rdyd_2059:
  s_mov_b32 s6, 65536
  v_mov_b32 v15, 8
L_sd_2060:
  buffer_load_dwordx3 v[12:14], v15, s[12:15], 0 offen sc1
  s_waitcnt vmcnt(0)
  v_readfirstlane_b32 s73, v14
  s_cmp_ge_u32 s73, 2
  s_cbranch_scc1 L_se_2061
  s_sleep 8
  s_sub_u32 s6, s6, 1
  s_cmp_lg_u32 s6, 0
  s_cbranch_scc1 L_sd_2060
  s_endpgm
L_se_2061:
  v_readfirstlane_b32 s73, v12
  s_cmp_gt_i32 s73, 0
  s_cselect_b32 s73, 0x2000, 0
  v_readfirstlane_b32 s74, v13
  s_mul_i32 s7, s3, 1280
  v_add_u32 v3, s7, v3
  s_add_u32 s7, s7, 10240
  v_and_b32 v12, 15, v1
  v_mul_u32_u24 v12, 40, v12
  v_bfe_u32 v13, v1, 4, 1
  v_lshl_add_u32 v12, v13, 3, v12
  v_lshrrev_b32 v13, 5, v1
  v_lshl_add_u32 v12, v13, 2, v12
  v_add_u32 v2, s7, v12
  s_lshl_b32 s7, s3, 9
  s_add_u32 s36, s36, s7
  s_lshl_b32 s32, s39, 3
  s_add_u32 s32, s32, s3
  s_lshl_b32 s32, s32, 11
  s_add_u32 s32, s32, 0x600000
  v_lshlrev_b32 v6, 7, v1
  s_mul_i32 s6, s39, 5
  s_add_u32 s6, s6, s3
  s_lshr_b32 s7, s6, 3
  s_lshl_b32 s7, s7, 14
  s_and_b32 s6, s6, 7
  s_lshl_b32 s6, s6, 10
  s_add_u32 s28, s6, s7
  s_add_u32 s28, s28, s73
  s_add_u32 s28, s28, 0x8400000
  s_and_b32 s57, s48, 3
  s_lshl_b32 s50, s57, 16
  s_lshl_b32 s51, s57, 18
  s_add_u32 s50, s50, s78
  s_add_u32 s51, s51, s79
  s_add_u32 s50, s50, s75
  s_mov_b32 s56, 524288
  v_mov_b32 v56, 0
  v_mov_b32 v57, 0
  v_mov_b32 v58, 0
  v_mov_b32 v59, 0
  v_mov_b32 v60, 0
  v_mov_b32 v61, 0
  v_mov_b32 v62, 0
  v_mov_b32 v63, 0
  s_setprio 1
  s_cmp_lt_u32 s3, 4
  s_cbranch_scc0 L_ap_2062
  s_setprio 3
L_ap_2062:
  s_barrier
  s_cmp_lg_u32 s74, 0
  s_cbranch_scc1 L_v_slow
  s_branch L_v_first
L_v_top:
  s_sleep 23
L_v_first:
  buffer_load_dwordx4 v[72:75], v9, s[8:11], s50 offen sc1
  buffer_load_dword v76, v0, s[8:11], s50 offen offset:1024 sc1
  s_nop 15
  s_nop 11
L_vm_l:
  buffer_load_dwordx4 v[78:81], v9, s[8:11], s50 offen sc1
  buffer_load_dword v82, v0, s[8:11], s50 offen offset:1024 sc1
  s_waitcnt vmcnt(2)
  v_max3_u32 v14, v72, v73, v74
  v_max3_u32 v14, v14, v75, v76
  v_cmp_eq_u32 vcc, -1, v14
  s_cbranch_vccnz L_vm_t
  ds_write_b128 v11, v[72:75]
  ds_write_b32 v10, v76 offset:1024
L_vm_o:
  s_waitcnt lgkmcnt(0)
  s_barrier
  s_add_u32 s53, s51, s36
  ds_read_b128 v[16:19], v9 offset:0
  ds_read_b128 v[20:23], v9 offset:1024
  ds_read_b128 v[24:27], v9 offset:2048
  ds_read_b128 v[28:31], v9 offset:3072
  ds_read_b128 v[32:35], v9 offset:4096
  ds_read_b128 v[36:39], v9 offset:5120
  ds_read_b128 v[40:43], v9 offset:6144
  ds_read_b128 v[44:47], v9 offset:7168
  ds_read_b128 v[48:51], v9 offset:8192
  ds_read_b128 v[52:55], v9 offset:9216
  s_waitcnt lgkmcnt(9)
  v_smfmac_f32_16x16x64_bf16 v[56:59], v[16:19], v[96:103], v4
  v_smfmac_f32_16x16x64_bf16 v[60:63], v[16:19], v[176:183], v4
  s_waitcnt lgkmcnt(8)
  v_smfmac_f32_16x16x64_bf16 v[56:59], v[20:23], v[104:111], v4
  v_smfmac_f32_16x16x64_bf16 v[60:63], v[20:23], v[184:191], v4
  s_waitcnt lgkmcnt(7)
  v_smfmac_f32_16x16x64_bf16 v[56:59], v[24:27], v[112:119], v4
  v_smfmac_f32_16x16x64_bf16 v[60:63], v[24:27], v[192:199], v4
  s_waitcnt lgkmcnt(6)
  v_smfmac_f32_16x16x64_bf16 v[56:59], v[28:31], v[120:127], v4
  v_smfmac_f32_16x16x64_bf16 v[60:63], v[28:31], v[200:207], v4
  s_waitcnt lgkmcnt(5)
  v_smfmac_f32_16x16x64_bf16 v[56:59], v[32:35], v[128:135], v4
  v_smfmac_f32_16x16x64_bf16 v[60:63], v[32:35], v[208:215], v4
  s_waitcnt lgkmcnt(4)
  v_smfmac_f32_16x16x64_bf16 v[56:59], v[36:39], v[136:143], v4
  v_smfmac_f32_16x16x64_bf16 v[60:63], v[36:39], v[216:223], v4
  s_waitcnt lgkmcnt(3)
  v_smfmac_f32_16x16x64_bf16 v[56:59], v[40:43], v[144:151], v4
  v_smfmac_f32_16x16x64_bf16 v[60:63], v[40:43], v[224:231], v4
  s_waitcnt lgkmcnt(2)
  v_smfmac_f32_16x16x64_bf16 v[56:59], v[44:47], v[152:159], v4
  v_smfmac_f32_16x16x64_bf16 v[60:63], v[44:47], v[232:239], v4
  s_waitcnt lgkmcnt(1)
  v_smfmac_f32_16x16x64_bf16 v[56:59], v[48:51], v[160:167], v4
  v_smfmac_f32_16x16x64_bf16 v[60:63], v[48:51], v[240:247], v4
  s_waitcnt lgkmcnt(0)
  v_smfmac_f32_16x16x64_bf16 v[56:59], v[52:55], v[168:175], v4
  v_smfmac_f32_16x16x64_bf16 v[60:63], v[52:55], v[248:255], v4
  s_nop 6
  v_permlane32_swap_b32 v56, v58
  v_permlane32_swap_b32 v57, v59
  v_permlane32_swap_b32 v60, v62
  v_permlane32_swap_b32 v61, v63
  v_pk_add_f32 v[56:57], v[56:57], v[58:59]
  v_pk_add_f32 v[60:61], v[60:61], v[62:63]
  v_cvt_pk_bf16_f32 v56, v56, v57
  v_cvt_pk_bf16_f32 v57, v60, v61
  ds_write2_b32 v2, v56, v57 offset1:160
  ds_read_b64_tr_b16 v[16:17], v3
  ds_read_b64_tr_b16 v[18:19], v3 offset:160
  s_waitcnt lgkmcnt(0)
  s_mov_b64 exec, s[60:61]
  v_min_u32 v19, -2, v19
  buffer_store_dwordx4 v[16:19], v5, s[8:11], s53 offen
  s_cmp_eq_u32 s48, 63
  s_cbranch_scc1 L_END
  s_add_u32 s34, s48, 3
  s_and_b32 s34, s34, 3
  s_lshl_b32 s34, s34, 18
  s_add_u32 s34, s34, s79
  s_add_u32 s34, s34, s36
  s_add_u32 s35, s48, 2
  s_and_b32 s35, s35, 3
  s_lshl_b32 s35, s35, 18
  s_add_u32 s35, s35, s28
  s_barrier
  buffer_store_dwordx4 v[88:91], v5, s[8:11], s34 offen
  s_mov_b64 exec, -1
  s_cmp_lt_u32 s3, 5
  s_cbranch_scc0 L_v_n3
  buffer_store_dwordx4 v[88:91], v9, s[8:11], s35 offen sc1
L_v_n3:
  s_mov_b64 exec, 0xffff
  buffer_load_dword v20, v6, s[8:11], s32 offen sc1
  s_mov_b64 exec, -1
  s_add_u32 s32, s32, 786432
  s_add_u32 s48, s48, 1
  s_and_b32 s57, s48, 3
  s_lshl_b32 s50, s57, 16
  s_lshl_b32 s51, s57, 18
  s_add_u32 s50, s50, s78
  s_add_u32 s51, s51, s79
  s_add_u32 s50, s50, s75
  s_mov_b32 s56, 524288
  v_mov_b32 v56, 0
  v_mov_b32 v57, 0
  v_mov_b32 v58, 0
  v_mov_b32 v59, 0
  v_mov_b32 v60, 0
  v_mov_b32 v61, 0
  v_mov_b32 v62, 0
  v_mov_b32 v63, 0
  s_waitcnt vmcnt(0)
  s_branch L_v_top
L_vm_t:
  buffer_load_dwordx4 v[72:75], v9, s[8:11], s50 offen sc1
  buffer_load_dword v76, v0, s[8:11], s50 offen offset:1024 sc1
  s_waitcnt vmcnt(2)
  v_max3_u32 v14, v78, v79, v80
  v_max3_u32 v14, v14, v81, v82
  v_cmp_eq_u32 vcc, -1, v14
  s_cbranch_vccz L_vm_b
  s_sub_u32 s56, s56, 1
  s_cmp_lg_u32 s56, 0
  s_cbranch_scc1 L_vm_l
  s_endpgm
L_vm_b:
  ds_write_b128 v11, v[78:81]
  ds_write_b32 v10, v82 offset:1024
  s_branch L_vm_o
L_v_slow:
  s_branch L_v_first_S
L_v_top_S:
  s_sleep 23
L_v_first_S:
  buffer_load_dwordx4 v[72:75], v9, s[8:11], s50 offen sc1
  buffer_load_dword v76, v0, s[8:11], s50 offen offset:1024 sc1
  s_nop 15
  s_nop 11
L_vm_l_S:
  buffer_load_dwordx4 v[78:81], v9, s[8:11], s50 offen sc1
  buffer_load_dword v82, v0, s[8:11], s50 offen offset:1024 sc1
  s_waitcnt vmcnt(2)
  v_max3_u32 v14, v72, v73, v74
  v_max3_u32 v14, v14, v75, v76
  v_cmp_eq_u32 vcc, -1, v14
  s_cbranch_vccnz L_vm_t_S
  ds_write_b128 v11, v[72:75]
  ds_write_b32 v10, v76 offset:1024
L_vm_o_S:
  s_waitcnt lgkmcnt(0)
  s_barrier
  s_add_u32 s53, s51, s36
  ds_read_b128 v[16:19], v9 offset:0
  ds_read_b128 v[20:23], v9 offset:1024
  ds_read_b128 v[24:27], v9 offset:2048
  ds_read_b128 v[28:31], v9 offset:3072
  ds_read_b128 v[32:35], v9 offset:4096
  ds_read_b128 v[36:39], v9 offset:5120
  ds_read_b128 v[40:43], v9 offset:6144
  ds_read_b128 v[44:47], v9 offset:7168
  ds_read_b128 v[48:51], v9 offset:8192
  ds_read_b128 v[52:55], v9 offset:9216
  s_waitcnt lgkmcnt(9)
  v_smfmac_f32_16x16x64_bf16 v[56:59], v[16:19], v[96:103], v4
  v_smfmac_f32_16x16x64_bf16 v[60:63], v[16:19], v[176:183], v4
  s_waitcnt lgkmcnt(8)
  v_smfmac_f32_16x16x64_bf16 v[56:59], v[20:23], v[104:111], v4
  v_smfmac_f32_16x16x64_bf16 v[60:63], v[20:23], v[184:191], v4
  s_waitcnt lgkmcnt(7)
  v_smfmac_f32_16x16x64_bf16 v[56:59], v[24:27], v[112:119], v4
  v_smfmac_f32_16x16x64_bf16 v[60:63], v[24:27], v[192:199], v4
  s_waitcnt lgkmcnt(6)
  v_smfmac_f32_16x16x64_bf16 v[56:59], v[28:31], v[120:127], v4
  v_smfmac_f32_16x16x64_bf16 v[60:63], v[28:31], v[200:207], v4
  s_waitcnt lgkmcnt(5)
  v_smfmac_f32_16x16x64_bf16 v[56:59], v[32:35], v[128:135], v4
  v_smfmac_f32_16x16x64_bf16 v[60:63], v[32:35], v[208:215], v4
  s_waitcnt lgkmcnt(4)
  v_smfmac_f32_16x16x64_bf16 v[56:59], v[36:39], v[136:143], v4
  v_smfmac_f32_16x16x64_bf16 v[60:63], v[36:39], v[216:223], v4
  s_waitcnt lgkmcnt(3)
  v_smfmac_f32_16x16x64_bf16 v[56:59], v[40:43], v[144:151], v4
  v_smfmac_f32_16x16x64_bf16 v[60:63], v[40:43], v[224:231], v4
  s_waitcnt lgkmcnt(2)
  v_smfmac_f32_16x16x64_bf16 v[56:59], v[44:47], v[152:159], v4
  v_smfmac_f32_16x16x64_bf16 v[60:63], v[44:47], v[232:239], v4
  s_waitcnt lgkmcnt(1)
  v_smfmac_f32_16x16x64_bf16 v[56:59], v[48:51], v[160:167], v4
  v_smfmac_f32_16x16x64_bf16 v[60:63], v[48:51], v[240:247], v4
  s_waitcnt lgkmcnt(0)
  v_smfmac_f32_16x16x64_bf16 v[56:59], v[52:55], v[168:175], v4
  v_smfmac_f32_16x16x64_bf16 v[60:63], v[52:55], v[248:255], v4
  s_nop 6
  v_permlane32_swap_b32 v56, v58
  v_permlane32_swap_b32 v57, v59
  v_permlane32_swap_b32 v60, v62
  v_permlane32_swap_b32 v61, v63
  v_pk_add_f32 v[56:57], v[56:57], v[58:59]
  v_pk_add_f32 v[60:61], v[60:61], v[62:63]
  v_cvt_pk_bf16_f32 v56, v56, v57
  v_cvt_pk_bf16_f32 v57, v60, v61
  ds_write2_b32 v2, v56, v57 offset1:160
  ds_read_b64_tr_b16 v[16:17], v3
  ds_read_b64_tr_b16 v[18:19], v3 offset:160
  s_waitcnt lgkmcnt(0)
  s_mov_b64 exec, s[60:61]
  v_min_u32 v19, -2, v19
  buffer_store_dwordx4 v[16:19], v5, s[8:11], s53 offen sc1
  s_cmp_eq_u32 s48, 63
  s_cbranch_scc1 L_END
  s_add_u32 s34, s48, 3
  s_and_b32 s34, s34, 3
  s_lshl_b32 s34, s34, 18
  s_add_u32 s34, s34, s79
  s_add_u32 s34, s34, s36
  s_add_u32 s35, s48, 2
  s_and_b32 s35, s35, 3
  s_lshl_b32 s35, s35, 18
  s_add_u32 s35, s35, s28
  s_barrier
  buffer_store_dwordx4 v[88:91], v5, s[8:11], s34 offen sc1
  s_mov_b64 exec, -1
  s_cmp_lt_u32 s3, 5
  s_cbranch_scc0 L_v_n3_S
  buffer_store_dwordx4 v[88:91], v9, s[8:11], s35 offen sc1
L_v_n3_S:
  s_mov_b64 exec, 0xffff
  buffer_load_dword v20, v6, s[8:11], s32 offen sc1
  s_mov_b64 exec, -1
  s_add_u32 s32, s32, 786432
  s_add_u32 s48, s48, 1
  s_and_b32 s57, s48, 3
  s_lshl_b32 s50, s57, 16
  s_lshl_b32 s51, s57, 18
  s_add_u32 s50, s50, s78
  s_add_u32 s51, s51, s79
  s_add_u32 s50, s50, s75
  s_mov_b32 s56, 524288
  v_mov_b32 v56, 0
  v_mov_b32 v57, 0
  v_mov_b32 v58, 0
  v_mov_b32 v59, 0
  v_mov_b32 v60, 0
  v_mov_b32 v61, 0
  v_mov_b32 v62, 0
  v_mov_b32 v63, 0
  s_waitcnt vmcnt(0)
  s_branch L_v_top_S
L_vm_t_S:
  buffer_load_dwordx4 v[72:75], v9, s[8:11], s50 offen sc1
  buffer_load_dword v76, v0, s[8:11], s50 offen offset:1024 sc1
  s_waitcnt vmcnt(2)
  v_max3_u32 v14, v78, v79, v80
  v_max3_u32 v14, v14, v81, v82
  v_cmp_eq_u32 vcc, -1, v14
  s_cbranch_vccz L_vm_b_S
  s_sub_u32 s56, s56, 1
  s_cmp_lg_u32 s56, 0
  s_cbranch_scc1 L_vm_l_S
  s_endpgm
L_vm_b_S:
  ds_write_b128 v11, v[78:81]
  ds_write_b32 v10, v82 offset:1024
  s_branch L_vm_o_S
L_END:
  s_endpgm
.section .rodata,"a"
.p2align 6
.amdhsa_kernel concat_heads__sliding_block__memory_aug_recurrent_mem_tr__prompt_kernel
  .amdhsa_next_free_vgpr 256
  .amdhsa_next_free_sgpr 102
  .amdhsa_accum_offset 256
  .amdhsa_group_segment_fixed_size 0
  .amdhsa_kernarg_size 104
  .amdhsa_user_sgpr_count 2
  .amdhsa_user_sgpr_kernarg_segment_ptr 1
  .amdhsa_system_sgpr_workgroup_id_x 1
  .amdhsa_float_denorm_mode_32 3
.end_amdhsa_kernel
```
